```python
import torch

def _softmax(x, axis=-1):
    return torch.softmax(x, dim=axis)
def _gelu(x):
    return torch.nn.functional.gelu(x, approximate="tanh")
def _silu(x):
    return torch.nn.functional.silu(x)
def _sigmoid(x):
    return torch.sigmoid(x)
def _layernorm(x, axis=-1, eps=1e-5):
    m = x.mean(dim=axis, keepdim=True)
    v = x.var(dim=axis, keepdim=True, unbiased=False)
    return (x - m) / torch.sqrt(v + eps)
def _scatter_add(tgt, idx, src, axis=0):
    return tgt.clone().index_add_(axis, idx, src)
def _segment_sum(src, seg, n):
    out = torch.zeros((n,) + src.shape[1:], dtype=src.dtype)
    return out.index_add_(0, seg, src)
def _pad(x, pw):
    flat = tuple(v for pair in reversed(pw) for v in pair)
    return torch.nn.functional.pad(x, flat)

kernel_name = 'recurrent_scan__compressed_kv_cla__dense_activation_gelu__decode'

def setup_inputs():

    _w = (lambda a: (lambda t: t.to(torch.bfloat16) if t.is_floating_point() else t)(torch.as_tensor(a)))
    def _A_setup():
        B, H, Sq, Sk, D, M = 2, 32, 1, 4096, 128, 512
        Dc = 4 * D
        return {
            "x": _w((lambda *s: torch.randn(*s, dtype=torch.bfloat16) * 0.1)(B, Sq, M)),
            "c_kv": _w((lambda *s: torch.randn(*s, dtype=torch.bfloat16) * 3.2)(B, Sk, Dc)),
            "w_q": _w((lambda *s: torch.randn(*s, dtype=torch.bfloat16) * 0.8)(M, H, D) * (M ** -0.5)),
            "w_uk": _w((lambda *s: torch.randn(*s, dtype=torch.bfloat16) * 0.8)(Dc, H, D) * (Dc ** -0.5)),
            "w_uv": _w((lambda *s: torch.randn(*s, dtype=torch.bfloat16) * 3.2)(Dc, H, D) * (Dc ** -0.5)),
            "w_o": _w((lambda *s: torch.randn(*s, dtype=torch.bfloat16) * 3.2)(H, D, M) * ((H * D) ** -0.5)),
        }
    _A_in = _A_setup()

    def _B_setup():
        B, S, D, F = 2, 1, 512, 1376
        return {
            "x": _w((lambda *s: torch.randn(*s, dtype=torch.bfloat16) * 0.1)(B, S, D)),
            "w1": _w((lambda *s: torch.randn(*s, dtype=torch.bfloat16) * 3.2)(D, F) * (D ** -0.5)),
            "b1": _w((lambda *s: torch.randn(*s, dtype=torch.bfloat16) * 3.2)(F) * 0.01),
            "w2": _w((lambda *s: torch.randn(*s, dtype=torch.bfloat16) * 3.2)(F, D) * (F ** -0.5)),
            "b2": _w((lambda *s: torch.randn(*s, dtype=torch.bfloat16) * 3.2)(D) * 0.01),
        }
    _B_in = _B_setup()

    return {
        "A_x": _A_in["x"],
        "A_c_kv": _A_in["c_kv"],
        "A_w_q": _A_in["w_q"],
        "A_w_uk": _A_in["w_uk"],
        "A_w_uv": _A_in["w_uv"],
        "A_w_o": _A_in["w_o"],
        "B_x": _B_in["x"],
        "B_w1": _B_in["w1"],
        "B_b1": _B_in["b1"],
        "B_w2": _B_in["w2"],
        "B_b2": _B_in["b2"],
    }

def reference(A_x, A_c_kv, A_w_q, A_w_uk, A_w_uv, A_w_o, B_x, B_w1, B_b1, B_w2, B_b2):
    def _A_ref(x, c_kv, w_q, w_uk, w_uv, w_o):
        B, Sq, M = x.shape[0], x.shape[1], x.shape[2]
        Sk = c_kv.shape[1]
        H, D = w_q.shape[1], w_q.shape[2]
        q = torch.einsum("bqm,mhd->bhqd", x, w_q)
        k = torch.einsum("bkc,chd->bhkd", c_kv, w_uk)
        v = torch.einsum("bkc,chd->bhkd", c_kv, w_uv)
        scores = torch.einsum("bhqd,bhkd->bhqk", q, k) * (D ** -0.5)
        off = Sk - Sq
        qi = torch.arange(Sq)[:, None]
        kj = torch.arange(Sk)[None, :]
        cmask = kj <= (qi + off)
        scores = torch.where(cmask[None, None], scores, -1e9)
        p = _softmax(scores, axis=-1)
        ctx = torch.einsum("bhqk,bhkd->bhqd", p, v)
        return torch.einsum("bhqd,hdm->bqm", ctx, w_o)

    def _B_ref(x, w1, b1, w2, b2):
        h = torch.einsum("bsd,df->bsf", x, w1) + b1
        h = _gelu(h)
        return torch.einsum("bsf,fd->bsd", h, w2) + b2

    x = A_x
    xn = _layernorm(x, axis=-1)
    s = _A_ref(xn, A_c_kv, A_w_q, A_w_uk, A_w_uv, A_w_o)
    g = _silu(_B_ref(xn, B_w1, B_b1, B_w2, B_b2))
    return x + s * g
```

```asm
; @launch grid=(256,1,1) block=(512,1,1) lds=163840
.amdgcn_target "amdgcn-amd-amdhsa--gfx950"
.text
.globl recurrent_scan__compressed_kv_cla__dense_activation_gelu__decode_kernel
.p2align 8
.type recurrent_scan__compressed_kv_cla__dense_activation_gelu__decode_kernel,@function
recurrent_scan__compressed_kv_cla__dense_activation_gelu__decode_kernel:
    s_mov_b32 s95, 0
    s_mov_b64 s[96:97], -1
L_pc0:
    s_cmp_ge_u32 s2, 256
    s_cbranch_scc1 L_end
    s_load_dwordx16 s[64:79], s[0:1], 0
    s_load_dwordx8 s[80:87], s[0:1], 64
    s_load_dwordx4 s[88:91], s[0:1], 96
    v_lshrrev_b32 v4, 6, v0
    v_and_b32 v1, 63, v0
    v_readfirstlane_b32 s44, v4
    v_lshrrev_b32 v2, 4, v1
    v_and_b32 v3, 15, v1
    v_mov_b32 v18, 0
    v_lshlrev_b32 v19, 4, v1
    s_mov_b32 s47, 0xfff
    s_mov_b32 s55, 0xfffff000
    s_mov_b32 s56, 0x07060302
    v_and_b32 v4, 1, v1
    v_lshlrev_b32 v4, 4, v4
    v_mov_b32 v5, 0xffff
    v_lshlrev_b32 v5, v4, v5
    v_bfe_u32 v4, v1, 1, 2
    v_cmp_eq_u32 vcc, 0, v4
    v_cndmask_b32 v8, 0, v5, vcc
    v_cmp_eq_u32 vcc, 1, v4
    v_cndmask_b32 v9, 0, v5, vcc
    v_cmp_eq_u32 vcc, 2, v4
    v_cndmask_b32 v10, 0, v5, vcc
    v_cmp_eq_u32 vcc, 3, v4
    v_cndmask_b32 v11, 0, v5, vcc
    s_waitcnt lgkmcnt(0)
    s_mov_b32 s8, s64
    s_mov_b32 s9, s65
    s_mov_b32 s10, 2048
    s_mov_b32 s11, 0x00020000
    s_mov_b32 s28, s90
    s_mov_b32 s29, s91
    s_mov_b32 s30, 16777216
    s_mov_b32 s31, 0x00020000
    s_mov_b32 s32, s88
    s_mov_b32 s33, s89
    s_mov_b32 s34, 256
    s_mov_b32 s35, 0x00020000
    s_or_b32 s48, s2, s44
    s_cmp_lg_u32 s48, 0
    s_cbranch_scc1 L_nonz
    s_memrealtime s[62:63]
    s_waitcnt lgkmcnt(0)
    s_or_b32 s62, s62, 1
    v_mov_b32 v16, s62
    v_mov_b32 v17, s63
    buffer_store_dwordx2 v[16:17], v18, s[32:35], 0 offen offset:128 sc0 sc1
L_nonz:
    s_and_b32 s48, s2, 7
    s_lshr_b32 s49, s2, 3
    s_cmp_ge_u32 s2, 128
    s_cbranch_scc1 L_roleB
    s_mov_b32 s12, s68
    s_mov_b32 s13, s69
    s_mov_b32 s14, 4194304
    s_mov_b32 s15, 0x00020000
    s_mov_b32 s16, s70
    s_mov_b32 s17, s71
    s_mov_b32 s18, 4194304
    s_mov_b32 s19, 0x00020000
    s_mov_b32 s20, s72
    s_mov_b32 s21, s73
    s_mov_b32 s22, 4194304
    s_mov_b32 s23, 0x00020000
    s_mov_b32 s24, s74
    s_mov_b32 s25, s75
    s_mov_b32 s26, 4194304
    s_mov_b32 s27, 0x00020000
    s_lshl_b32 s45, s48, 2
    s_lshr_b32 s60, s49, 2
    s_add_u32 s45, s45, s60
    s_and_b32 s46, s49, 3
    s_mul_i32 s94, s48, 6
    s_add_u32 s94, s94, s49
    s_cmp_ge_u32 s49, 6
    s_cselect_b32 s94, 63, s94
    s_cmp_ge_u32 s44, 2
    s_cbranch_scc1 L_nox
    s_lshl_b32 s51, s44, 10
    buffer_load_dwordx4 v[20:23], v19, s[8:11], s51 offen
L_nox:
    v_lshrrev_b32 v54, 2, v1
    v_and_b32 v4, 3, v1
    v_lshlrev_b32 v5, 13, v54
    v_lshl_add_u32 v5, v4, 4, v5
    s_lshl_b32 s48, s44, 19
    s_lshl_b32 s49, s45, 8
    s_add_u32 s48, s48, s49
    s_lshl_b32 s60, s46, 6
    s_add_u32 s48, s48, s60
    v_lshlrev_b32 v5, 13, v2
    v_lshl_add_u32 v5, v3, 4, v5
    s_lshl_b32 s48, s46, 20
    s_add_u32 s48, s48, s49
    s_lshl_b32 s60, s44, 17
    s_add_u32 s48, s48, s60
    s_add_u32 s60, s48, 0
    buffer_load_dwordx4 v[64:67], v5, s[12:15], s60 offen nt
    s_add_u32 s60, s48, 32768
    buffer_load_dwordx4 v[68:71], v5, s[12:15], s60 offen nt
    s_add_u32 s60, s48, 65536
    buffer_load_dwordx4 v[72:75], v5, s[12:15], s60 offen nt
    s_add_u32 s60, s48, 98304
    buffer_load_dwordx4 v[76:79], v5, s[12:15], s60 offen nt
    v_lshlrev_b32 v52, 15, v2
    v_lshl_add_u32 v52, v3, 4, v52
    v_lshlrev_b32 v53, 13, v3
    v_lshl_add_u32 v53, v2, 4, v53
    s_lshl_b32 s48, s46, 20
    s_add_u32 s48, s48, s49
    s_lshl_b32 s60, s44, 17
    s_add_u32 s54, s48, s60
    s_barrier
    s_cmp_eq_u32 s44, 0
    s_cbranch_scc1 L_nouk
    s_cmp_lg_u32 s44, 1
    s_cbranch_scc1 L_wqok
    s_waitcnt vmcnt(4)
    v_lshlrev_b32 v28, 16, v20
    v_and_b32 v29, 0xffff0000, v20
    v_lshlrev_b32 v30, 16, v21
    v_and_b32 v31, 0xffff0000, v21
    v_lshlrev_b32 v32, 16, v22
    v_and_b32 v33, 0xffff0000, v22
    v_lshlrev_b32 v34, 16, v23
    v_and_b32 v35, 0xffff0000, v23
    v_pk_add_f32 v[36:37], v[28:29], v[30:31]
    v_pk_add_f32 v[38:39], v[32:33], v[34:35]
    v_pk_add_f32 v[36:37], v[36:37], v[38:39]
    v_add_f32 v36, v36, v37
    s_nop 1
    v_add_f32_dpp v36, v36, v36 row_ror:8 row_mask:0xf bank_mask:0xf
    s_nop 1
    v_add_f32_dpp v36, v36, v36 row_ror:4 row_mask:0xf bank_mask:0xf
    s_nop 1
    v_add_f32_dpp v36, v36, v36 row_ror:2 row_mask:0xf bank_mask:0xf
    s_nop 1
    v_add_f32_dpp v36, v36, v36 row_ror:1 row_mask:0xf bank_mask:0xf
    v_mov_b32 v38, v36
    s_nop 1
    v_permlane16_swap_b32 v36, v38
    s_nop 1
    v_add_f32 v36, v36, v38
    v_mov_b32 v38, v36
    s_nop 1
    v_permlane32_swap_b32 v36, v38
    s_nop 1
    v_add_f32 v36, v36, v38
    v_mul_f32 v36, 0x3b000000, v36
    v_sub_f32 v38, v28, v36
    v_sub_f32 v39, v29, v36
    v_sub_f32 v40, v30, v36
    v_sub_f32 v41, v31, v36
    v_pk_mul_f32 v[42:43], v[38:39], v[38:39]
    v_pk_fma_f32 v[42:43], v[40:41], v[40:41], v[42:43]
    v_sub_f32 v38, v32, v36
    v_sub_f32 v39, v33, v36
    v_sub_f32 v40, v34, v36
    v_sub_f32 v41, v35, v36
    v_pk_fma_f32 v[42:43], v[38:39], v[38:39], v[42:43]
    v_pk_fma_f32 v[42:43], v[40:41], v[40:41], v[42:43]
    v_add_f32 v38, v42, v43
    s_nop 1
    v_add_f32_dpp v38, v38, v38 row_ror:8 row_mask:0xf bank_mask:0xf
    s_nop 1
    v_add_f32_dpp v38, v38, v38 row_ror:4 row_mask:0xf bank_mask:0xf
    s_nop 1
    v_add_f32_dpp v38, v38, v38 row_ror:2 row_mask:0xf bank_mask:0xf
    s_nop 1
    v_add_f32_dpp v38, v38, v38 row_ror:1 row_mask:0xf bank_mask:0xf
    v_mov_b32 v40, v38
    s_nop 1
    v_permlane16_swap_b32 v38, v40
    s_nop 1
    v_add_f32 v38, v38, v40
    v_mov_b32 v40, v38
    s_nop 1
    v_permlane32_swap_b32 v38, v40
    s_nop 1
    v_add_f32 v38, v38, v40
    v_mul_f32 v38, 0x3b000000, v38
    v_cvt_pk_bf16_f32 v38, v38, v38
    v_and_b32 v38, 0xffff0000, v38
    v_add_f32 v38, 0x3727c5ac, v38
    v_cvt_pk_bf16_f32 v38, v38, v38
    v_and_b32 v38, 0xffff0000, v38
    v_sqrt_f32 v38, v38
    v_cvt_pk_bf16_f32 v36, v36, v36
    v_and_b32 v36, 0xffff0000, v36
    v_cvt_pk_bf16_f32 v38, v38, v38
    v_and_b32 v38, 0xffff0000, v38
    v_rcp_f32 v38, v38
    v_sub_f32 v28, v28, v36
    v_sub_f32 v29, v29, v36
    v_sub_f32 v30, v30, v36
    v_sub_f32 v31, v31, v36
    v_sub_f32 v32, v32, v36
    v_sub_f32 v33, v33, v36
    v_sub_f32 v34, v34, v36
    v_sub_f32 v35, v35, v36
    v_cvt_pk_bf16_f32 v20, v28, v29
    v_cvt_pk_bf16_f32 v21, v30, v31
    v_cvt_pk_bf16_f32 v22, v32, v33
    v_cvt_pk_bf16_f32 v23, v34, v35
    v_lshlrev_b32 v28, 16, v20
    v_and_b32 v29, 0xffff0000, v20
    v_lshlrev_b32 v30, 16, v21
    v_and_b32 v31, 0xffff0000, v21
    v_lshlrev_b32 v32, 16, v22
    v_and_b32 v33, 0xffff0000, v22
    v_lshlrev_b32 v34, 16, v23
    v_and_b32 v35, 0xffff0000, v23
    v_mul_f32 v28, v28, v38
    v_mul_f32 v29, v29, v38
    v_mul_f32 v30, v30, v38
    v_mul_f32 v31, v31, v38
    v_mul_f32 v32, v32, v38
    v_mul_f32 v33, v33, v38
    v_mul_f32 v34, v34, v38
    v_mul_f32 v35, v35, v38
    v_cvt_pk_bf16_f32 v20, v28, v29
    v_cvt_pk_bf16_f32 v21, v30, v31
    v_cvt_pk_bf16_f32 v22, v32, v33
    v_cvt_pk_bf16_f32 v23, v34, v35
    v_add_u32 v36, s51, v19
    ds_write_b128 v36, v[20:23] offset:0
    s_branch L_wqok
L_nouk:
    s_waitcnt vmcnt(4)
    v_lshlrev_b32 v28, 16, v20
    v_and_b32 v29, 0xffff0000, v20
    v_lshlrev_b32 v30, 16, v21
    v_and_b32 v31, 0xffff0000, v21
    v_lshlrev_b32 v32, 16, v22
    v_and_b32 v33, 0xffff0000, v22
    v_lshlrev_b32 v34, 16, v23
    v_and_b32 v35, 0xffff0000, v23
    v_pk_add_f32 v[36:37], v[28:29], v[30:31]
    v_pk_add_f32 v[38:39], v[32:33], v[34:35]
    v_pk_add_f32 v[36:37], v[36:37], v[38:39]
    v_add_f32 v36, v36, v37
    s_nop 1
    v_add_f32_dpp v36, v36, v36 row_ror:8 row_mask:0xf bank_mask:0xf
    s_nop 1
    v_add_f32_dpp v36, v36, v36 row_ror:4 row_mask:0xf bank_mask:0xf
    s_nop 1
    v_add_f32_dpp v36, v36, v36 row_ror:2 row_mask:0xf bank_mask:0xf
    s_nop 1
    v_add_f32_dpp v36, v36, v36 row_ror:1 row_mask:0xf bank_mask:0xf
    v_mov_b32 v38, v36
    s_nop 1
    v_permlane16_swap_b32 v36, v38
    s_nop 1
    v_add_f32 v36, v36, v38
    v_mov_b32 v38, v36
    s_nop 1
    v_permlane32_swap_b32 v36, v38
    s_nop 1
    v_add_f32 v36, v36, v38
    v_mul_f32 v36, 0x3b000000, v36
    v_sub_f32 v38, v28, v36
    v_sub_f32 v39, v29, v36
    v_sub_f32 v40, v30, v36
    v_sub_f32 v41, v31, v36
    v_pk_mul_f32 v[42:43], v[38:39], v[38:39]
    v_pk_fma_f32 v[42:43], v[40:41], v[40:41], v[42:43]
    v_sub_f32 v38, v32, v36
    v_sub_f32 v39, v33, v36
    v_sub_f32 v40, v34, v36
    v_sub_f32 v41, v35, v36
    v_pk_fma_f32 v[42:43], v[38:39], v[38:39], v[42:43]
    v_pk_fma_f32 v[42:43], v[40:41], v[40:41], v[42:43]
    v_add_f32 v38, v42, v43
    s_nop 1
    v_add_f32_dpp v38, v38, v38 row_ror:8 row_mask:0xf bank_mask:0xf
    s_nop 1
    v_add_f32_dpp v38, v38, v38 row_ror:4 row_mask:0xf bank_mask:0xf
    s_nop 1
    v_add_f32_dpp v38, v38, v38 row_ror:2 row_mask:0xf bank_mask:0xf
    s_nop 1
    v_add_f32_dpp v38, v38, v38 row_ror:1 row_mask:0xf bank_mask:0xf
    v_mov_b32 v40, v38
    s_nop 1
    v_permlane16_swap_b32 v38, v40
    s_nop 1
    v_add_f32 v38, v38, v40
    v_mov_b32 v40, v38
    s_nop 1
    v_permlane32_swap_b32 v38, v40
    s_nop 1
    v_add_f32 v38, v38, v40
    v_mul_f32 v38, 0x3b000000, v38
    v_cvt_pk_bf16_f32 v38, v38, v38
    v_and_b32 v38, 0xffff0000, v38
    v_add_f32 v38, 0x3727c5ac, v38
    v_cvt_pk_bf16_f32 v38, v38, v38
    v_and_b32 v38, 0xffff0000, v38
    v_sqrt_f32 v38, v38
    v_cvt_pk_bf16_f32 v36, v36, v36
    v_and_b32 v36, 0xffff0000, v36
    v_cvt_pk_bf16_f32 v38, v38, v38
    v_and_b32 v38, 0xffff0000, v38
    v_rcp_f32 v38, v38
    v_sub_f32 v28, v28, v36
    v_sub_f32 v29, v29, v36
    v_sub_f32 v30, v30, v36
    v_sub_f32 v31, v31, v36
    v_sub_f32 v32, v32, v36
    v_sub_f32 v33, v33, v36
    v_sub_f32 v34, v34, v36
    v_sub_f32 v35, v35, v36
    v_cvt_pk_bf16_f32 v20, v28, v29
    v_cvt_pk_bf16_f32 v21, v30, v31
    v_cvt_pk_bf16_f32 v22, v32, v33
    v_cvt_pk_bf16_f32 v23, v34, v35
    v_lshlrev_b32 v28, 16, v20
    v_and_b32 v29, 0xffff0000, v20
    v_lshlrev_b32 v30, 16, v21
    v_and_b32 v31, 0xffff0000, v21
    v_lshlrev_b32 v32, 16, v22
    v_and_b32 v33, 0xffff0000, v22
    v_lshlrev_b32 v34, 16, v23
    v_and_b32 v35, 0xffff0000, v23
    v_mul_f32 v28, v28, v38
    v_mul_f32 v29, v29, v38
    v_mul_f32 v30, v30, v38
    v_mul_f32 v31, v31, v38
    v_mul_f32 v32, v32, v38
    v_mul_f32 v33, v33, v38
    v_mul_f32 v34, v34, v38
    v_mul_f32 v35, v35, v38
    v_cvt_pk_bf16_f32 v20, v28, v29
    v_cvt_pk_bf16_f32 v21, v30, v31
    v_cvt_pk_bf16_f32 v22, v32, v33
    v_cvt_pk_bf16_f32 v23, v34, v35
    v_add_u32 v36, s51, v19
    ds_write_b128 v36, v[20:23] offset:0
    buffer_load_dwordx2 v[16:17], v18, s[32:35], 0 offen offset:128 sc0 sc1
L_wqok:
    v_lshrrev_b32 v4, 3, v3
    v_lshlrev_b32 v4, 10, v4
    v_lshl_add_u32 v4, v2, 1, v4
    s_lshl_b32 s48, s46, 8
    s_lshl_b32 s60, s44, 5
    s_add_u32 s48, s48, s60
    v_add_u32 v4, s48, v4
    s_lshl_b32 s48, s44, 10
    v_add_u32 v51, s48, v19
    s_waitcnt lgkmcnt(0)
    s_barrier
    ds_read_u16 v28, v4 offset:0
    ds_read_u16 v29, v4 offset:8
    ds_read_u16 v30, v4 offset:16
    ds_read_u16 v31, v4 offset:24
    s_waitcnt lgkmcnt(0)
    v_lshl_or_b32 v28, v28, 16, v28
    v_lshl_or_b32 v29, v29, 16, v29
    v_lshl_or_b32 v30, v30, 16, v30
    v_lshl_or_b32 v31, v31, 16, v31
    v_and_b32 v32, v28, v8
    v_and_b32 v33, v28, v9
    v_and_b32 v34, v28, v10
    v_and_b32 v35, v28, v11
    v_and_b32 v36, v29, v8
    v_and_b32 v37, v29, v9
    v_and_b32 v38, v29, v10
    v_and_b32 v39, v29, v11
    v_and_b32 v40, v30, v8
    v_and_b32 v41, v30, v9
    v_and_b32 v42, v30, v10
    v_and_b32 v43, v30, v11
    v_and_b32 v44, v31, v8
    v_and_b32 v45, v31, v9
    v_and_b32 v46, v31, v10
    v_and_b32 v47, v31, v11
    s_cmp_eq_u32 s44, 0
    s_cbranch_scc1 L_wq0
    s_cmp_eq_u32 s44, 4
    s_cbranch_scc1 L_wq4
    s_waitcnt vmcnt(0)
    s_branch L_wq8
L_wq0:
    s_waitcnt vmcnt(1)
    s_branch L_wq8
L_wq4:
    s_waitcnt vmcnt(0)
L_wq8:
    s_cmp_eq_u32 s44, 0
    s_cbranch_scc1 L_nouk2
    s_sub_u32 s48, s54, 524288
    s_add_u32 s60, s54, 0
    buffer_load_dwordx4 v[128:131], v52, s[16:19], s60 offen nt
    s_add_u32 s60, s54, 8192
    buffer_load_dwordx4 v[132:135], v52, s[16:19], s60 offen nt
    s_add_u32 s60, s54, 16384
    buffer_load_dwordx4 v[136:139], v52, s[16:19], s60 offen nt
    s_add_u32 s60, s54, 24576
    buffer_load_dwordx4 v[140:143], v52, s[16:19], s60 offen nt
    s_cmp_lg_u32 s44, 4
    s_cbranch_scc1 L_nouk2
    s_add_u32 s60, s48, 0
    buffer_load_dwordx4 v[80:83], v52, s[16:19], s60 offen nt
    s_add_u32 s60, s48, 8192
    buffer_load_dwordx4 v[84:87], v52, s[16:19], s60 offen nt
    s_add_u32 s60, s48, 16384
    buffer_load_dwordx4 v[88:91], v52, s[16:19], s60 offen nt
    s_add_u32 s60, s48, 24576
    buffer_load_dwordx4 v[92:95], v52, s[16:19], s60 offen nt
    s_branch L_nouk2
L_nouk2:
    v_mfma_f32_16x16x32_bf16 v[56:59], v[32:35], v[64:67], 0
    v_mfma_f32_16x16x32_bf16 v[56:59], v[36:39], v[68:71], v[56:59]
    v_mfma_f32_16x16x32_bf16 v[56:59], v[40:43], v[72:75], v[56:59]
    v_mfma_f32_16x16x32_bf16 v[56:59], v[44:47], v[76:79], v[56:59]
    s_nop 7
    s_nop 2
    ds_write_b128 v51, v[56:59] offset:32768
    v_and_b32 v6, 1, v3
    v_lshlrev_b32 v6, 8, v6
    v_lshl_add_u32 v6, v2, 4, v6
    v_lshlrev_b32 v7, 16, v3
    v_and_b32 v4, 1, v2
    v_lshl_add_u32 v7, v4, 10, v7
    v_lshrrev_b32 v4, 1, v2
    v_lshl_add_u32 v7, v4, 8, v7
    s_lshr_b32 s48, s45, 4
    s_lshl_b32 s48, s48, 15
    s_lshl_b32 s49, s46, 13
    s_add_u32 s48, s48, s49
    s_and_b32 s49, s45, 15
    s_lshl_b32 s49, s49, 4
    s_add_u32 s48, s48, s49
    s_add_u32 s52, s48, 0
    s_lshr_b32 s60, s44, 1
    s_lshl_b32 s60, s60, 11
    s_and_b32 s49, s44, 1
    s_lshl_b32 s49, s49, 9
    s_add_u32 s60, s60, s49
    s_add_u32 s53, s52, s60
    s_cmp_lg_u32 s44, 0
    s_cbranch_scc1 L_notw0
    s_mov_b32 s50, 0
nz_1:
    s_waitcnt vmcnt(0)
nzf_3:
    v_cmp_eq_u32 vcc, 0, v16
    s_cbranch_vccz nzd_2
    s_add_u32 s50, s50, 1
    s_cmp_gt_u32 s50, 200000
    s_cbranch_scc1 nzd_2
    s_sleep 1
    buffer_load_dwordx2 v[16:17], v18, s[32:35], 0 offen offset:128 sc0 sc1
    s_branch nz_1
nzd_2:
    v_and_b32 v12, s47, v16
    v_bfe_u32 v13, v16, 12, 12
    v_alignbit_b32 v4, v17, v16, 24
    v_and_b32 v14, s47, v4
    v_bfe_u32 v15, v17, 4, 12
    ds_write_b64 v18, v[16:17] offset:8192
    s_lshl_b32 s48, s45, 12
    s_add_u32 s48, s48, 393216
    s_lshl_b32 s49, s46, 10
    s_add_u32 s49, s49, s48
    v_lshrrev_b32 v5, 1, v2
    v_lshlrev_b32 v5, 8, v5
    v_lshl_add_u32 v5, v3, 4, v5
    v_and_b32 v44, 1, v2
    v_lshl_add_u32 v5, v44, 3, v5
    s_waitcnt lgkmcnt(0)
    s_barrier
    ds_read_b128 v[160:163], v19 offset:32768
    ds_read_b128 v[164:167], v19 offset:33792
    ds_read_b128 v[168:171], v19 offset:34816
    ds_read_b128 v[172:175], v19 offset:35840
    ds_read_b128 v[176:179], v19 offset:36864
    ds_read_b128 v[180:183], v19 offset:37888
    ds_read_b128 v[184:187], v19 offset:38912
    ds_read_b128 v[188:191], v19 offset:39936
    s_waitcnt lgkmcnt(0)
    v_add_f32 v160, v160, v164
    v_add_f32 v168, v168, v172
    v_add_f32 v176, v176, v180
    v_add_f32 v184, v184, v188
    v_add_f32 v161, v161, v165
    v_add_f32 v169, v169, v173
    v_add_f32 v177, v177, v181
    v_add_f32 v185, v185, v189
    v_add_f32 v162, v162, v166
    v_add_f32 v170, v170, v174
    v_add_f32 v178, v178, v182
    v_add_f32 v186, v186, v190
    v_add_f32 v163, v163, v167
    v_add_f32 v171, v171, v175
    v_add_f32 v179, v179, v183
    v_add_f32 v187, v187, v191
    v_add_f32 v160, v160, v168
    v_add_f32 v176, v176, v184
    v_add_f32 v161, v161, v169
    v_add_f32 v177, v177, v185
    v_add_f32 v162, v162, v170
    v_add_f32 v178, v178, v186
    v_add_f32 v163, v163, v171
    v_add_f32 v179, v179, v187
    v_add_f32 v28, v160, v176
    v_add_f32 v29, v161, v177
    v_add_f32 v30, v162, v178
    v_add_f32 v31, v163, v179
    v_add_u32 v28, 0x800, v28
    v_add_u32 v29, 0x800, v29
    v_add_u32 v30, 0x800, v30
    v_add_u32 v31, 0x800, v31
    v_bfi_b32 v28, s47, v12, v28
    v_bfi_b32 v29, s47, v13, v29
    v_bfi_b32 v30, s47, v14, v30
    v_bfi_b32 v31, s47, v15, v31
    buffer_store_dwordx4 v[28:31], v19, s[28:31], s49 offen sc0 sc1
    s_waitcnt lgkmcnt(0)
    s_barrier
    s_branch L_qdone
L_notw0:
    s_waitcnt lgkmcnt(0)
    s_barrier
    ds_read_b64 v[16:17], v18 offset:8192
    s_waitcnt lgkmcnt(0)
    v_and_b32 v12, s47, v16
    v_bfe_u32 v13, v16, 12, 12
    v_alignbit_b32 v4, v17, v16, 24
    v_and_b32 v14, s47, v4
    v_bfe_u32 v15, v17, 4, 12
    s_lshl_b32 s48, s44, 12
    s_add_u32 s48, s48, 98304
    v_lshlrev_b32 v4, 2, v2
    v_xor_b32 v4, v4, v3
    v_lshlrev_b32 v4, 4, v4
    v_lshl_add_u32 v4, v2, 10, v4
    v_add_u32 v32, s48, v4
    v_xor_b32 v33, 16, v32
    v_xor_b32 v34, 32, v32
    v_xor_b32 v35, 48, v32
    v_xor_b32 v4, v2, v3
    v_lshlrev_b32 v4, 4, v4
    v_lshl_add_u32 v4, v3, 8, v4
    v_add_u32 v36, s48, v4
    v_xor_b32 v37, 64, v36
    v_xor_b32 v38, 0x80, v36
    v_xor_b32 v39, 0xc0, v36
    s_waitcnt vmcnt(0)
    ds_write_b128 v32, v[128:131] offset:0
    ds_write_b128 v33, v[132:135] offset:256
    ds_write_b128 v34, v[136:139] offset:512
    ds_write_b128 v35, v[140:143] offset:768
    ds_read_b128 v[128:131], v36
    ds_read_b128 v[132:135], v37
    ds_read_b128 v[136:139], v38
    ds_read_b128 v[140:143], v39
    s_cmp_lg_u32 s44, 4
    s_cbranch_scc1 L_nore2
    ds_write_b128 v32, v[80:83] offset:16384
    ds_write_b128 v33, v[84:87] offset:16640
    ds_write_b128 v34, v[88:91] offset:16896
    ds_write_b128 v35, v[92:95] offset:17152
    ds_read_b128 v[80:83], v36 offset:16384
    ds_read_b128 v[84:87], v37 offset:16384
    ds_read_b128 v[88:91], v38 offset:16384
    ds_read_b128 v[92:95], v39 offset:16384
L_nore2:
    s_cmp_lg_u32 s44, 2
    s_cbranch_scc1 L_nopq
    s_lshl_b32 s48, s45, 12
    s_add_u32 s48, s48, 393216
    v_lshrrev_b32 v5, 1, v2
    v_lshlrev_b32 v5, 8, v5
    v_lshl_add_u32 v5, v3, 4, v5
    v_and_b32 v44, 1, v2
    v_lshl_add_u32 v5, v44, 3, v5
    s_waitcnt lgkmcnt(0)
    s_mov_b32 s50, 0
    s_mov_b64 s[92:93], exec
pl_4:
    buffer_load_dwordx4 v[28:31], v19, s[28:31], s48 offen offset:0 sc0 sc1
    buffer_load_dwordx4 v[32:35], v19, s[28:31], s48 offen offset:1024 sc0 sc1
    buffer_load_dwordx4 v[36:39], v19, s[28:31], s48 offen offset:2048 sc0 sc1
    buffer_load_dwordx4 v[40:43], v19, s[28:31], s48 offen offset:3072 sc0 sc1
plf_6:
    s_waitcnt vmcnt(0)
    v_xor_b32 v45, v28, v12
    v_xor_b32 v46, v29, v13
    v_xor_b32 v47, v30, v14
    v_xor_b32 v48, v31, v15
    v_or3_b32 v44, v45, v46, v47
    v_or_b32 v44, v44, v48
    v_xor_b32 v45, v32, v12
    v_xor_b32 v46, v33, v13
    v_xor_b32 v47, v34, v14
    v_xor_b32 v48, v35, v15
    v_or3_b32 v44, v44, v45, v46
    v_or3_b32 v44, v44, v47, v48
    v_xor_b32 v45, v36, v12
    v_xor_b32 v46, v37, v13
    v_xor_b32 v47, v38, v14
    v_xor_b32 v48, v39, v15
    v_or3_b32 v44, v44, v45, v46
    v_or3_b32 v44, v44, v47, v48
    v_xor_b32 v45, v40, v12
    v_xor_b32 v46, v41, v13
    v_xor_b32 v47, v42, v14
    v_xor_b32 v48, v43, v15
    v_or3_b32 v44, v44, v45, v46
    v_or3_b32 v44, v44, v47, v48
    v_and_b32 v44, s47, v44
    v_cmp_ne_u32 vcc, 0, v44
    s_cbranch_vccz pld_5
    s_mov_b64 exec, vcc
    s_add_u32 s50, s50, 1
    s_cmp_gt_u32 s50, 200000
    s_cbranch_scc0 pl_4
pld_5:
    s_mov_b64 exec, s[92:93]
    v_and_b32 v28, s55, v28
    v_and_b32 v29, s55, v29
    v_and_b32 v30, s55, v30
    v_and_b32 v31, s55, v31
    v_and_b32 v32, s55, v32
    v_and_b32 v33, s55, v33
    v_and_b32 v34, s55, v34
    v_and_b32 v35, s55, v35
    v_and_b32 v36, s55, v36
    v_and_b32 v37, s55, v37
    v_and_b32 v38, s55, v38
    v_and_b32 v39, s55, v39
    v_and_b32 v40, s55, v40
    v_and_b32 v41, s55, v41
    v_and_b32 v42, s55, v42
    v_and_b32 v43, s55, v43
    v_add_f32 v28, v28, v32
    v_add_f32 v36, v36, v40
    v_add_f32 v29, v29, v33
    v_add_f32 v37, v37, v41
    v_add_f32 v30, v30, v34
    v_add_f32 v38, v38, v42
    v_add_f32 v31, v31, v35
    v_add_f32 v39, v39, v43
    v_add_f32 v28, v28, v36
    v_add_f32 v29, v29, v37
    v_add_f32 v30, v30, v38
    v_add_f32 v31, v31, v39
    v_cvt_pk_bf16_f32 v28, v28, v29
    v_cvt_pk_bf16_f32 v29, v30, v31
    ds_write_b64 v5, v[28:29] offset:4096
L_nopq:
    s_waitcnt lgkmcnt(0)
    s_barrier
    ds_read_b128 v[32:35], v6 offset:4096
    ds_read_b128 v[36:39], v6 offset:4160
    ds_read_b128 v[40:43], v6 offset:4224
    ds_read_b128 v[44:47], v6 offset:4288
    v_cmp_gt_u32 vcc, 2, v3
    s_mov_b64 s[58:59], vcc
    s_waitcnt lgkmcnt(0)
    v_mfma_f32_16x16x32_bf16 v[60:63], v[128:131], v[32:35], 0
    v_mfma_f32_16x16x32_bf16 v[60:63], v[132:135], v[36:39], v[60:63]
    v_mfma_f32_16x16x32_bf16 v[60:63], v[136:139], v[40:43], v[60:63]
    v_mfma_f32_16x16x32_bf16 v[60:63], v[140:143], v[44:47], v[60:63]
    s_nop 7
    s_nop 2
    v_cvt_pk_bf16_f32 v28, v60, v60
    v_cvt_pk_bf16_f32 v29, v61, v61
    v_cvt_pk_bf16_f32 v30, v62, v62
    v_cvt_pk_bf16_f32 v31, v63, v63
    v_bfi_b32 v28, s47, v12, v28
    v_bfi_b32 v29, s47, v13, v29
    v_bfi_b32 v30, s47, v14, v30
    v_bfi_b32 v31, s47, v15, v31
    s_mov_b64 exec, s[58:59]
    buffer_store_dwordx4 v[28:31], v7, s[28:31], s53 offen sc0 sc1
    s_mov_b64 exec, -1
    s_cmp_lg_u32 s44, 4
    s_cbranch_scc1 L_qdone
    v_mfma_f32_16x16x32_bf16 v[60:63], v[80:83], v[32:35], 0
    v_mfma_f32_16x16x32_bf16 v[60:63], v[84:87], v[36:39], v[60:63]
    v_mfma_f32_16x16x32_bf16 v[60:63], v[88:91], v[40:43], v[60:63]
    v_mfma_f32_16x16x32_bf16 v[60:63], v[92:95], v[44:47], v[60:63]
    s_nop 7
    s_nop 2
    v_cvt_pk_bf16_f32 v28, v60, v60
    v_cvt_pk_bf16_f32 v29, v61, v61
    v_cvt_pk_bf16_f32 v30, v62, v62
    v_cvt_pk_bf16_f32 v31, v63, v63
    v_bfi_b32 v28, s47, v12, v28
    v_bfi_b32 v29, s47, v13, v29
    v_bfi_b32 v30, s47, v14, v30
    v_bfi_b32 v31, s47, v15, v31
    s_mov_b64 exec, s[58:59]
    buffer_store_dwordx4 v[28:31], v7, s[28:31], s52 offen sc0 sc1
    s_mov_b64 exec, -1
L_qdone:
    s_barrier
    s_cmp_lg_u32 s44, 0
    s_cbranch_scc1 L_noqf
    v_lshlrev_b32 v4, 11, v1
    s_lshr_b32 s48, s45, 4
    s_lshl_b32 s48, s48, 10
    s_and_b32 s49, s45, 15
    s_lshl_b32 s49, s49, 6
    s_add_u32 s48, s48, s49
    s_lshl_b32 s49, s46, 4
    s_add_u32 s48, s48, s49
    s_add_u32 s48, s48, 1572864
    buffer_store_dwordx4 v[12:15], v4, s[28:31], s48 offen sc0 sc1
L_noqf:
    s_barrier
    s_add_u32 s60, s54, 0
    buffer_load_dwordx4 v[144:147], v52, s[20:23], s60 offen nt
    s_add_u32 s60, s54, 8192
    buffer_load_dwordx4 v[148:151], v52, s[20:23], s60 offen nt
    s_add_u32 s60, s54, 16384
    buffer_load_dwordx4 v[152:155], v52, s[20:23], s60 offen nt
    s_add_u32 s60, s54, 24576
    buffer_load_dwordx4 v[156:159], v52, s[20:23], s60 offen nt
    s_cmp_ge_u32 s44, 4
    s_cbranch_scc1 L_nowo
    v_lshlrev_b32 v53, 12, v2
    v_lshl_add_u32 v53, v3, 4, v53
    s_lshl_b32 s48, s45, 17
    s_lshl_b32 s49, s44, 8
    s_add_u32 s48, s48, s49
    s_add_u32 s60, s48, 0
    buffer_load_dwordx4 v[64:67], v53, s[24:27], s60 offen offset:0 nt
    buffer_load_dwordx4 v[68:71], v53, s[24:27], s60 offen offset:1024 nt
    buffer_load_dwordx4 v[72:75], v53, s[24:27], s60 offen offset:2048 nt
    buffer_load_dwordx4 v[76:79], v53, s[24:27], s60 offen offset:3072 nt
    s_add_u32 s60, s48, 16384
    buffer_load_dwordx4 v[80:83], v53, s[24:27], s60 offen offset:0 nt
    buffer_load_dwordx4 v[84:87], v53, s[24:27], s60 offen offset:1024 nt
    buffer_load_dwordx4 v[88:91], v53, s[24:27], s60 offen offset:2048 nt
    buffer_load_dwordx4 v[92:95], v53, s[24:27], s60 offen offset:3072 nt
    s_add_u32 s60, s48, 32768
    buffer_load_dwordx4 v[96:99], v53, s[24:27], s60 offen offset:0 nt
    buffer_load_dwordx4 v[100:103], v53, s[24:27], s60 offen offset:1024 nt
    buffer_load_dwordx4 v[104:107], v53, s[24:27], s60 offen offset:2048 nt
    buffer_load_dwordx4 v[108:111], v53, s[24:27], s60 offen offset:3072 nt
    s_add_u32 s60, s48, 49152
    buffer_load_dwordx4 v[112:115], v53, s[24:27], s60 offen offset:0 nt
    buffer_load_dwordx4 v[116:119], v53, s[24:27], s60 offen offset:1024 nt
    buffer_load_dwordx4 v[120:123], v53, s[24:27], s60 offen offset:2048 nt
    buffer_load_dwordx4 v[124:127], v53, s[24:27], s60 offen offset:3072 nt
    s_add_u32 s60, s48, 65536
    buffer_load_dwordx4 v[160:163], v53, s[24:27], s60 offen offset:0 nt
    buffer_load_dwordx4 v[164:167], v53, s[24:27], s60 offen offset:1024 nt
    buffer_load_dwordx4 v[168:171], v53, s[24:27], s60 offen offset:2048 nt
    buffer_load_dwordx4 v[172:175], v53, s[24:27], s60 offen offset:3072 nt
    s_add_u32 s60, s48, 81920
    buffer_load_dwordx4 v[176:179], v53, s[24:27], s60 offen offset:0 nt
    buffer_load_dwordx4 v[180:183], v53, s[24:27], s60 offen offset:1024 nt
    buffer_load_dwordx4 v[184:187], v53, s[24:27], s60 offen offset:2048 nt
    buffer_load_dwordx4 v[188:191], v53, s[24:27], s60 offen offset:3072 nt
    s_add_u32 s60, s48, 98304
    buffer_load_dwordx4 v[192:195], v53, s[24:27], s60 offen offset:0 nt
    buffer_load_dwordx4 v[196:199], v53, s[24:27], s60 offen offset:1024 nt
    buffer_load_dwordx4 v[200:203], v53, s[24:27], s60 offen offset:2048 nt
    buffer_load_dwordx4 v[204:207], v53, s[24:27], s60 offen offset:3072 nt
    s_add_u32 s60, s48, 114688
    buffer_load_dwordx4 v[208:211], v53, s[24:27], s60 offen offset:0 nt
    buffer_load_dwordx4 v[212:215], v53, s[24:27], s60 offen offset:1024 nt
    buffer_load_dwordx4 v[216:219], v53, s[24:27], s60 offen offset:2048 nt
    buffer_load_dwordx4 v[220:223], v53, s[24:27], s60 offen offset:3072 nt
L_nowo:
L_mlpdone:
L_Apass:
    v_lshrrev_b32 v4, 5, v1
    v_lshlrev_b32 v4, 14, v4
    v_and_b32 v5, 31, v1
    v_lshl_add_u32 v4, v5, 4, v4
    s_lshl_b32 s48, s45, 2
    s_add_u32 s48, s48, s46
    s_lshl_b32 s48, s48, 15
    s_lshl_b32 s49, s44, 11
    s_add_u32 s48, s48, s49
    s_add_u32 s48, s48, 2097152
    s_lshl_b32 s49, s45, 10
    s_add_u32 s49, s49, 262144
    v_and_b32 v6, 32, v1
    s_lshl_b32 s60, s44, 2
    v_add_u32 v6, s60, v6
    v_lshlrev_b32 v6, 2, v6
    s_cmp_lg_u32 s44, 0
    s_cbranch_scc1 sne_9
    s_mov_b32 s50, s95
sn_7:
    buffer_load_dwordx4 v[36:39], v19, s[28:31], s49 offen sc0 sc1
    s_waitcnt vmcnt(0)
    v_xor_b32 v41, v36, v12
    v_xor_b32 v42, v37, v13
    v_xor_b32 v43, v38, v14
    v_xor_b32 v44, v39, v15
    v_or3_b32 v40, v41, v42, v43
    v_or_b32 v40, v40, v44
    v_and_b32 v40, s47, v40
    v_cmp_eq_u32 vcc, 0, v40
    s_bcnt1_i32_b64 s61, vcc
    s_cmp_ge_u32 s61, 64
    s_cbranch_scc1 snd_8
    s_add_u32 s50, s50, 1
    s_cmp_gt_u32 s50, 200000
    s_cbranch_scc1 snd_8
    s_sleep 2
    s_branch sn_7
snd_8:
    ds_write_b64 v19, v[36:37] offset:40960
    s_waitcnt lgkmcnt(0)
sne_9:
    s_barrier
    s_mov_b32 s50, 0
    s_mov_b64 s[64:65], s[96:97]
    s_mov_b64 s[66:67], s[96:97]
    s_mov_b64 s[68:69], s[96:97]
    s_mov_b64 s[70:71], s[96:97]
    buffer_load_dwordx4 v[20:23], v4, s[28:31], s48 offen offset:0 sc0 sc1
    buffer_load_dwordx4 v[24:27], v4, s[28:31], s48 offen offset:512 sc0 sc1
    buffer_load_dwordx4 v[28:31], v4, s[28:31], s48 offen offset:1024 sc0 sc1
    buffer_load_dwordx4 v[32:35], v4, s[28:31], s48 offen offset:1536 sc0 sc1
    ds_read_b64 v[36:37], v19 offset:40960
    s_waitcnt lgkmcnt(0)
    v_and_b32 v50, s55, v36
    v_and_b32 v51, s55, v37
    v_mov_b32 v45, v50
    s_nop 1
    v_max_f32_dpp v45, v45, v45 row_ror:8 row_mask:0xf bank_mask:0xf
    s_nop 1
    v_max_f32_dpp v45, v45, v45 row_ror:4 row_mask:0xf bank_mask:0xf
    s_nop 1
    v_max_f32_dpp v45, v45, v45 row_ror:2 row_mask:0xf bank_mask:0xf
    s_nop 1
    v_max_f32_dpp v45, v45, v45 row_ror:1 row_mask:0xf bank_mask:0xf
    v_mov_b32 v46, v45
    s_nop 1
    v_permlane16_swap_b32 v45, v46
    s_nop 1
    v_max_f32 v45, v45, v46
    v_sub_f32 v45, v50, v45
    v_exp_f32 v45, v45
    s_nop 0
    v_mul_f32 v46, v45, v51
    s_nop 1
    v_add_f32_dpp v46, v46, v46 row_ror:8 row_mask:0xf bank_mask:0xf
    s_nop 1
    v_add_f32_dpp v46, v46, v46 row_ror:4 row_mask:0xf bank_mask:0xf
    s_nop 1
    v_add_f32_dpp v46, v46, v46 row_ror:2 row_mask:0xf bank_mask:0xf
    s_nop 1
    v_add_f32_dpp v46, v46, v46 row_ror:1 row_mask:0xf bank_mask:0xf
    v_mov_b32 v47, v46
    s_nop 1
    v_permlane16_swap_b32 v46, v47
    s_nop 1
    v_add_f32 v46, v46, v47
    v_rcp_f32 v46, v46
    s_nop 0
    v_mul_f32 v45, v45, v46
    ds_bpermute_b32 v46, v6, v45 offset:0
    ds_bpermute_b32 v47, v6, v45 offset:4
    ds_bpermute_b32 v48, v6, v45 offset:8
    ds_bpermute_b32 v49, v6, v45 offset:12
    s_branch pmc_12
pm_10:
    s_mov_b64 exec, s[64:65]
    s_cbranch_execz pk_13
    buffer_load_dwordx4 v[20:23], v4, s[28:31], s48 offen offset:0 sc0 sc1
pk_13:
    s_mov_b64 exec, s[66:67]
    s_cbranch_execz pk_14
    buffer_load_dwordx4 v[24:27], v4, s[28:31], s48 offen offset:512 sc0 sc1
pk_14:
    s_mov_b64 exec, s[68:69]
    s_cbranch_execz pk_15
    buffer_load_dwordx4 v[28:31], v4, s[28:31], s48 offen offset:1024 sc0 sc1
pk_15:
    s_mov_b64 exec, s[70:71]
    s_cbranch_execz pk_16
    buffer_load_dwordx4 v[32:35], v4, s[28:31], s48 offen offset:1536 sc0 sc1
pk_16:
pmc_12:
    s_waitcnt vmcnt(0)
    s_mov_b64 s[92:93], 0
    s_mov_b64 exec, s[64:65]
    s_cbranch_execz pc_17
    v_xor_b32 v41, v20, v12
    v_xor_b32 v42, v21, v13
    v_xor_b32 v43, v22, v14
    v_xor_b32 v44, v23, v15
    v_or3_b32 v40, v41, v42, v43
    v_or_b32 v40, v40, v44
    v_and_b32 v40, s47, v40
    v_cmp_ne_u32 vcc, 0, v40
    s_mov_b64 s[64:65], vcc
    s_or_b64 s[92:93], s[92:93], vcc
pc_17:
    s_mov_b64 exec, s[66:67]
    s_cbranch_execz pc_18
    v_xor_b32 v41, v24, v12
    v_xor_b32 v42, v25, v13
    v_xor_b32 v43, v26, v14
    v_xor_b32 v44, v27, v15
    v_or3_b32 v40, v41, v42, v43
    v_or_b32 v40, v40, v44
    v_and_b32 v40, s47, v40
    v_cmp_ne_u32 vcc, 0, v40
    s_mov_b64 s[66:67], vcc
    s_or_b64 s[92:93], s[92:93], vcc
pc_18:
    s_mov_b64 exec, s[68:69]
    s_cbranch_execz pc_19
    v_xor_b32 v41, v28, v12
    v_xor_b32 v42, v29, v13
    v_xor_b32 v43, v30, v14
    v_xor_b32 v44, v31, v15
    v_or3_b32 v40, v41, v42, v43
    v_or_b32 v40, v40, v44
    v_and_b32 v40, s47, v40
    v_cmp_ne_u32 vcc, 0, v40
    s_mov_b64 s[68:69], vcc
    s_or_b64 s[92:93], s[92:93], vcc
pc_19:
    s_mov_b64 exec, s[70:71]
    s_cbranch_execz pc_20
    v_xor_b32 v41, v32, v12
    v_xor_b32 v42, v33, v13
    v_xor_b32 v43, v34, v14
    v_xor_b32 v44, v35, v15
    v_or3_b32 v40, v41, v42, v43
    v_or_b32 v40, v40, v44
    v_and_b32 v40, s47, v40
    v_cmp_ne_u32 vcc, 0, v40
    s_mov_b64 s[70:71], vcc
    s_or_b64 s[92:93], s[92:93], vcc
pc_20:
    s_cmp_eq_u64 s[92:93], 0
    s_cbranch_scc1 pmd_11
    s_add_u32 s50, s50, 1
    s_cmp_gt_u32 s50, 200000
    s_cbranch_scc0 pm_10
pmd_11:
    s_mov_b64 exec, s[96:97]
    v_and_b32 v20, s55, v20
    v_and_b32 v21, s55, v21
    v_and_b32 v22, s55, v22
    v_and_b32 v23, s55, v23
    v_and_b32 v24, s55, v24
    v_and_b32 v25, s55, v25
    v_and_b32 v26, s55, v26
    v_and_b32 v27, s55, v27
    v_and_b32 v28, s55, v28
    v_and_b32 v29, s55, v29
    v_and_b32 v30, s55, v30
    v_and_b32 v31, s55, v31
    v_and_b32 v32, s55, v32
    v_and_b32 v33, s55, v33
    v_and_b32 v34, s55, v34
    v_and_b32 v35, s55, v35
    s_waitcnt lgkmcnt(0)
    v_mul_f32 v60, v46, v20
    v_mul_f32 v61, v46, v21
    v_mul_f32 v62, v46, v22
    v_mul_f32 v63, v46, v23
    v_fma_f32 v60, v47, v24, v60
    v_fma_f32 v61, v47, v25, v61
    v_fma_f32 v62, v47, v26, v62
    v_fma_f32 v63, v47, v27, v63
    v_fma_f32 v60, v48, v28, v60
    v_fma_f32 v61, v48, v29, v61
    v_fma_f32 v62, v48, v30, v62
    v_fma_f32 v63, v48, v31, v63
    v_fma_f32 v60, v49, v32, v60
    v_fma_f32 v61, v49, v33, v61
    v_fma_f32 v62, v49, v34, v62
    v_fma_f32 v63, v49, v35, v63
    s_lshl_b32 s48, s44, 10
    v_add_u32 v5, s48, v19
    ds_write_b128 v5, v[60:63] offset:20480
    v_lshrrev_b32 v4, 3, v3
    v_lshlrev_b32 v4, 5, v4
    v_add_u32 v4, v4, v2
    s_lshl_b32 s60, s44, 2
    v_add_u32 v4, s60, v4
    v_lshlrev_b32 v4, 4, v4
    s_waitcnt lgkmcnt(0)
    s_barrier
    ds_read_b128 v[20:23], v4 offset:20480
    ds_read_b128 v[24:27], v4 offset:21504
    ds_read_b128 v[28:31], v4 offset:22528
    ds_read_b128 v[32:35], v4 offset:23552
    ds_read_b128 v[36:39], v4 offset:24576
    ds_read_b128 v[40:43], v4 offset:25600
    ds_read_b128 v[44:47], v4 offset:26624
    ds_read_b128 v[48:51], v4 offset:27648
    s_waitcnt lgkmcnt(0)
    v_add_f32 v20, v20, v24
    v_add_f32 v28, v28, v32
    v_add_f32 v36, v36, v40
    v_add_f32 v44, v44, v48
    v_add_f32 v21, v21, v25
    v_add_f32 v29, v29, v33
    v_add_f32 v37, v37, v41
    v_add_f32 v45, v45, v49
    v_add_f32 v22, v22, v26
    v_add_f32 v30, v30, v34
    v_add_f32 v38, v38, v42
    v_add_f32 v46, v46, v50
    v_add_f32 v23, v23, v27
    v_add_f32 v31, v31, v35
    v_add_f32 v39, v39, v43
    v_add_f32 v47, v47, v51
    v_add_f32 v20, v20, v28
    v_add_f32 v36, v36, v44
    v_add_f32 v21, v21, v29
    v_add_f32 v37, v37, v45
    v_add_f32 v22, v22, v30
    v_add_f32 v38, v38, v46
    v_add_f32 v23, v23, v31
    v_add_f32 v39, v39, v47
    v_add_f32 v52, v20, v36
    v_add_f32 v53, v21, v37
    v_add_f32 v54, v22, v38
    v_add_f32 v55, v23, v39
    v_cvt_pk_bf16_f32 v52, v52, v52
    v_cvt_pk_bf16_f32 v53, v53, v53
    v_cvt_pk_bf16_f32 v54, v54, v54
    v_cvt_pk_bf16_f32 v55, v55, v55
    v_and_b32 v128, v52, v8
    v_and_b32 v129, v52, v9
    v_and_b32 v130, v52, v10
    v_and_b32 v131, v52, v11
    s_nop 1
    v_mfma_f32_16x16x32_bf16 v[60:63], v[128:131], v[144:147], 0
    v_and_b32 v132, v53, v8
    v_and_b32 v133, v53, v9
    v_and_b32 v134, v53, v10
    v_and_b32 v135, v53, v11
    s_nop 1
    v_mfma_f32_16x16x32_bf16 v[60:63], v[132:135], v[148:151], v[60:63]
    v_and_b32 v136, v54, v8
    v_and_b32 v137, v54, v9
    v_and_b32 v138, v54, v10
    v_and_b32 v139, v54, v11
    s_nop 1
    v_mfma_f32_16x16x32_bf16 v[60:63], v[136:139], v[152:155], v[60:63]
    v_and_b32 v140, v55, v8
    v_and_b32 v141, v55, v9
    v_and_b32 v142, v55, v10
    v_and_b32 v143, v55, v11
    s_nop 1
    v_mfma_f32_16x16x32_bf16 v[60:63], v[140:143], v[156:159], v[60:63]
    s_nop 7
    s_nop 2
    ds_write_b128 v5, v[60:63] offset:28672
    s_waitcnt lgkmcnt(0)
    s_barrier
    s_cmp_ge_u32 s44, 4
    s_cbranch_scc1 L_endA
    ds_read_b128 v[20:23], v19 offset:28672
    ds_read_b128 v[24:27], v19 offset:29696
    ds_read_b128 v[28:31], v19 offset:30720
    ds_read_b128 v[32:35], v19 offset:31744
    ds_read_b128 v[36:39], v19 offset:32768
    ds_read_b128 v[40:43], v19 offset:33792
    ds_read_b128 v[44:47], v19 offset:34816
    ds_read_b128 v[48:51], v19 offset:35840
    v_lshrrev_b32 v4, 1, v2
    v_lshlrev_b32 v4, 9, v4
    v_lshl_add_u32 v4, v3, 5, v4
    v_and_b32 v6, 1, v2
    v_lshl_add_u32 v4, v6, 4, v4
    v_add_u32 v4, s48, v4
    v_lshrrev_b32 v6, 3, v3
    v_lshlrev_b32 v6, 9, v6
    v_lshl_add_u32 v6, v2, 4, v6
    v_add_u32 v6, s48, v6
    s_waitcnt lgkmcnt(0)
    v_add_f32 v20, v20, v24
    v_add_f32 v28, v28, v32
    v_add_f32 v36, v36, v40
    v_add_f32 v44, v44, v48
    v_add_f32 v21, v21, v25
    v_add_f32 v29, v29, v33
    v_add_f32 v37, v37, v41
    v_add_f32 v45, v45, v49
    v_add_f32 v22, v22, v26
    v_add_f32 v30, v30, v34
    v_add_f32 v38, v38, v42
    v_add_f32 v46, v46, v50
    v_add_f32 v23, v23, v27
    v_add_f32 v31, v31, v35
    v_add_f32 v39, v39, v43
    v_add_f32 v47, v47, v51
    v_add_f32 v20, v20, v28
    v_add_f32 v36, v36, v44
    v_add_f32 v21, v21, v29
    v_add_f32 v37, v37, v45
    v_add_f32 v22, v22, v30
    v_add_f32 v38, v38, v46
    v_add_f32 v23, v23, v31
    v_add_f32 v39, v39, v47
    v_add_f32 v52, v20, v36
    v_add_f32 v53, v21, v37
    v_add_f32 v54, v22, v38
    v_add_f32 v55, v23, v39
    v_cvt_pk_bf16_f32 v52, v52, v52
    v_cvt_pk_bf16_f32 v53, v53, v53
    v_cvt_pk_bf16_f32 v54, v54, v54
    v_cvt_pk_bf16_f32 v55, v55, v55
    ds_write_b128 v4, v[52:55] offset:12288
    s_waitcnt lgkmcnt(0)
    ds_read_b128 v[20:23], v6 offset:12288
    ds_read_b128 v[24:27], v6 offset:12352
    ds_read_b128 v[28:31], v6 offset:12416
    ds_read_b128 v[32:35], v6 offset:12480
    ds_read_b128 v[36:39], v6 offset:12544
    ds_read_b128 v[40:43], v6 offset:12608
    ds_read_b128 v[44:47], v6 offset:12672
    ds_read_b128 v[48:51], v6 offset:12736
    v_lshrrev_b32 v4, 1, v2
    v_lshlrev_b32 v4, 5, v4
    v_lshrrev_b32 v5, 1, v3
    v_add_u32 v4, v4, v5
    v_lshlrev_b32 v4, 13, v4
    v_and_b32 v5, 1, v3
    v_lshl_add_u32 v4, v5, 5, v4
    v_and_b32 v5, 1, v2
    v_lshl_add_u32 v4, v5, 4, v4
    s_lshl_b32 s48, s45, 2
    s_add_u32 s48, s48, s46
    s_lshl_b32 s48, s48, 6
    s_lshl_b32 s49, s44, 16
    s_add_u32 s48, s48, s49
    s_add_u32 s48, s48, 524288
    s_waitcnt lgkmcnt(0)
    v_and_b32 v128, v20, v8
    v_and_b32 v129, v20, v9
    v_and_b32 v130, v20, v10
    v_and_b32 v131, v20, v11
    v_and_b32 v132, v21, v8
    v_and_b32 v133, v21, v9
    v_and_b32 v134, v21, v10
    v_and_b32 v135, v21, v11
    v_mfma_f32_16x16x32_bf16 v[56:59], v[128:131], v[64:67], 0
    v_and_b32 v136, v22, v8
    v_and_b32 v137, v22, v9
    v_and_b32 v138, v22, v10
    v_and_b32 v139, v22, v11
    v_mfma_f32_16x16x32_bf16 v[60:63], v[132:135], v[68:71], 0
    v_and_b32 v140, v23, v8
    v_and_b32 v141, v23, v9
    v_and_b32 v142, v23, v10
    v_and_b32 v143, v23, v11
    v_mfma_f32_16x16x32_bf16 v[56:59], v[136:139], v[72:75], v[56:59]
    v_and_b32 v128, v24, v8
    v_and_b32 v129, v24, v9
    v_and_b32 v130, v24, v10
    v_and_b32 v131, v24, v11
    v_mfma_f32_16x16x32_bf16 v[60:63], v[140:143], v[76:79], v[60:63]
    v_and_b32 v132, v25, v8
    v_and_b32 v133, v25, v9
    v_and_b32 v134, v25, v10
    v_and_b32 v135, v25, v11
    v_mfma_f32_16x16x32_bf16 v[56:59], v[128:131], v[80:83], v[56:59]
    v_and_b32 v136, v26, v8
    v_and_b32 v137, v26, v9
    v_and_b32 v138, v26, v10
    v_and_b32 v139, v26, v11
    v_mfma_f32_16x16x32_bf16 v[60:63], v[132:135], v[84:87], v[60:63]
    v_and_b32 v140, v27, v8
    v_and_b32 v141, v27, v9
    v_and_b32 v142, v27, v10
    v_and_b32 v143, v27, v11
    v_mfma_f32_16x16x32_bf16 v[56:59], v[136:139], v[88:91], v[56:59]
    v_and_b32 v128, v28, v8
    v_and_b32 v129, v28, v9
    v_and_b32 v130, v28, v10
    v_and_b32 v131, v28, v11
    v_mfma_f32_16x16x32_bf16 v[60:63], v[140:143], v[92:95], v[60:63]
    v_and_b32 v132, v29, v8
    v_and_b32 v133, v29, v9
    v_and_b32 v134, v29, v10
    v_and_b32 v135, v29, v11
    v_mfma_f32_16x16x32_bf16 v[56:59], v[128:131], v[96:99], v[56:59]
    v_and_b32 v136, v30, v8
    v_and_b32 v137, v30, v9
    v_and_b32 v138, v30, v10
    v_and_b32 v139, v30, v11
    v_mfma_f32_16x16x32_bf16 v[60:63], v[132:135], v[100:103], v[60:63]
    v_and_b32 v140, v31, v8
    v_and_b32 v141, v31, v9
    v_and_b32 v142, v31, v10
    v_and_b32 v143, v31, v11
    v_mfma_f32_16x16x32_bf16 v[56:59], v[136:139], v[104:107], v[56:59]
    v_and_b32 v128, v32, v8
    v_and_b32 v129, v32, v9
    v_and_b32 v130, v32, v10
    v_and_b32 v131, v32, v11
    v_mfma_f32_16x16x32_bf16 v[60:63], v[140:143], v[108:111], v[60:63]
    v_and_b32 v132, v33, v8
    v_and_b32 v133, v33, v9
    v_and_b32 v134, v33, v10
    v_and_b32 v135, v33, v11
    v_mfma_f32_16x16x32_bf16 v[56:59], v[128:131], v[112:115], v[56:59]
    v_and_b32 v136, v34, v8
    v_and_b32 v137, v34, v9
    v_and_b32 v138, v34, v10
    v_and_b32 v139, v34, v11
    v_mfma_f32_16x16x32_bf16 v[60:63], v[132:135], v[116:119], v[60:63]
    v_and_b32 v140, v35, v8
    v_and_b32 v141, v35, v9
    v_and_b32 v142, v35, v10
    v_and_b32 v143, v35, v11
    v_mfma_f32_16x16x32_bf16 v[56:59], v[136:139], v[120:123], v[56:59]
    v_and_b32 v128, v36, v8
    v_and_b32 v129, v36, v9
    v_and_b32 v130, v36, v10
    v_and_b32 v131, v36, v11
    v_mfma_f32_16x16x32_bf16 v[60:63], v[140:143], v[124:127], v[60:63]
    v_and_b32 v132, v37, v8
    v_and_b32 v133, v37, v9
    v_and_b32 v134, v37, v10
    v_and_b32 v135, v37, v11
    v_mfma_f32_16x16x32_bf16 v[56:59], v[128:131], v[160:163], v[56:59]
    v_and_b32 v136, v38, v8
    v_and_b32 v137, v38, v9
    v_and_b32 v138, v38, v10
    v_and_b32 v139, v38, v11
    v_mfma_f32_16x16x32_bf16 v[60:63], v[132:135], v[164:167], v[60:63]
    v_and_b32 v140, v39, v8
    v_and_b32 v141, v39, v9
    v_and_b32 v142, v39, v10
    v_and_b32 v143, v39, v11
    v_mfma_f32_16x16x32_bf16 v[56:59], v[136:139], v[168:171], v[56:59]
    v_and_b32 v128, v40, v8
    v_and_b32 v129, v40, v9
    v_and_b32 v130, v40, v10
    v_and_b32 v131, v40, v11
    v_mfma_f32_16x16x32_bf16 v[60:63], v[140:143], v[172:175], v[60:63]
    v_and_b32 v132, v41, v8
    v_and_b32 v133, v41, v9
    v_and_b32 v134, v41, v10
    v_and_b32 v135, v41, v11
    v_mfma_f32_16x16x32_bf16 v[56:59], v[128:131], v[176:179], v[56:59]
    v_and_b32 v136, v42, v8
    v_and_b32 v137, v42, v9
    v_and_b32 v138, v42, v10
    v_and_b32 v139, v42, v11
    v_mfma_f32_16x16x32_bf16 v[60:63], v[132:135], v[180:183], v[60:63]
    v_and_b32 v140, v43, v8
    v_and_b32 v141, v43, v9
    v_and_b32 v142, v43, v10
    v_and_b32 v143, v43, v11
    v_mfma_f32_16x16x32_bf16 v[56:59], v[136:139], v[184:187], v[56:59]
    v_and_b32 v128, v44, v8
    v_and_b32 v129, v44, v9
    v_and_b32 v130, v44, v10
    v_and_b32 v131, v44, v11
    v_mfma_f32_16x16x32_bf16 v[60:63], v[140:143], v[188:191], v[60:63]
    v_and_b32 v132, v45, v8
    v_and_b32 v133, v45, v9
    v_and_b32 v134, v45, v10
    v_and_b32 v135, v45, v11
    v_mfma_f32_16x16x32_bf16 v[56:59], v[128:131], v[192:195], v[56:59]
    v_and_b32 v136, v46, v8
    v_and_b32 v137, v46, v9
    v_and_b32 v138, v46, v10
    v_and_b32 v139, v46, v11
    v_mfma_f32_16x16x32_bf16 v[60:63], v[132:135], v[196:199], v[60:63]
    v_and_b32 v140, v47, v8
    v_and_b32 v141, v47, v9
    v_and_b32 v142, v47, v10
    v_and_b32 v143, v47, v11
    v_mfma_f32_16x16x32_bf16 v[56:59], v[136:139], v[200:203], v[56:59]
    v_and_b32 v128, v48, v8
    v_and_b32 v129, v48, v9
    v_and_b32 v130, v48, v10
    v_and_b32 v131, v48, v11
    v_mfma_f32_16x16x32_bf16 v[60:63], v[140:143], v[204:207], v[60:63]
    v_and_b32 v132, v49, v8
    v_and_b32 v133, v49, v9
    v_and_b32 v134, v49, v10
    v_and_b32 v135, v49, v11
    v_mfma_f32_16x16x32_bf16 v[56:59], v[128:131], v[208:211], v[56:59]
    v_and_b32 v136, v50, v8
    v_and_b32 v137, v50, v9
    v_and_b32 v138, v50, v10
    v_and_b32 v139, v50, v11
    v_mfma_f32_16x16x32_bf16 v[60:63], v[132:135], v[212:215], v[60:63]
    v_and_b32 v140, v51, v8
    v_and_b32 v141, v51, v9
    v_and_b32 v142, v51, v10
    v_and_b32 v143, v51, v11
    v_mfma_f32_16x16x32_bf16 v[56:59], v[136:139], v[216:219], v[56:59]
    s_nop 1
    v_mfma_f32_16x16x32_bf16 v[60:63], v[140:143], v[220:223], v[60:63]
    s_nop 7
    s_nop 2
    v_add_f32 v56, v56, v60
    v_add_f32 v57, v57, v61
    v_add_f32 v58, v58, v62
    v_add_f32 v59, v59, v63
    v_bfi_b32 v52, s47, v12, v56
    v_bfi_b32 v53, s47, v13, v57
    v_bfi_b32 v54, s47, v14, v58
    v_bfi_b32 v55, s47, v15, v59
    buffer_store_dwordx4 v[52:55], v4, s[28:31], s48 offen sc0 sc1
L_endA:
    s_cmp_eq_u32 s95, 0
    s_cbranch_scc1 L_end
    s_mov_b32 s95, 0
    s_mov_b64 s[96:97], -1
    s_mov_b64 exec, -1
    s_branch L_Apass
L_roleB:
    s_mov_b32 s12, s66
    s_mov_b32 s13, s67
    s_mov_b32 s14, 8388608
    s_mov_b32 s15, 0x00020000
    s_mov_b32 s40, s84
    s_mov_b32 s41, s85
    s_mov_b32 s42, 1024
    s_mov_b32 s43, 0x00020000
    s_mov_b32 s36, s86
    s_mov_b32 s37, s87
    s_mov_b32 s38, 2048
    s_mov_b32 s39, 0x00020000
    s_mov_b32 s16, s78
    s_mov_b32 s17, s79
    s_mov_b32 s18, 1409024
    s_mov_b32 s19, 0x00020000
    s_mov_b32 s20, s82
    s_mov_b32 s21, s83
    s_mov_b32 s22, 1409024
    s_mov_b32 s23, 0x00020000
    s_mov_b32 s24, s80
    s_mov_b32 s25, s81
    s_mov_b32 s26, 2752
    s_mov_b32 s27, 0x00020000
    s_sub_u32 s54, s2, 128
    s_sub_u32 s49, s49, 16
    s_and_b32 s53, s49, 1
    s_lshr_b32 s49, s49, 1
    s_lshl_b32 s52, s48, 3
    s_add_u32 s52, s52, s49
    s_lshr_b32 s51, s52, 5
    v_lshlrev_b32 v52, 10, v3
    v_lshl_add_u32 v52, v2, 4, v52
    s_and_b32 s61, s54, 7
    s_mul_i32 s94, s61, 6
    s_lshr_b32 s61, s54, 3
    s_add_u32 s94, s94, s61
    s_cmp_ge_u32 s61, 6
    s_cselect_b32 s94, 63, s94
    s_cmp_ge_u32 s94, 43
    s_cbranch_scc1 L_bnox
    s_cmp_ge_u32 s44, 2
    s_cbranch_scc1 L_bnox
    s_lshl_b32 s61, s44, 10
    buffer_load_dwordx4 v[20:23], v19, s[8:11], s61 offen
L_bnox:
    s_lshl_b32 s48, s52, 17
    s_lshl_b32 s49, s44, 7
    s_add_u32 s48, s48, s49
    v_lshrrev_b32 v5, 3, v1
    v_lshlrev_b32 v52, 10, v5
    v_and_b32 v4, 7, v1
    v_lshl_add_u32 v52, v4, 4, v52
    s_add_u32 s60, s48, 0
    buffer_load_dwordx4 v[64:67], v52, s[12:15], s60 offen nt
    s_add_u32 s60, s48, 8192
    buffer_load_dwordx4 v[68:71], v52, s[12:15], s60 offen nt
    s_add_u32 s60, s48, 16384
    buffer_load_dwordx4 v[72:75], v52, s[12:15], s60 offen nt
    s_add_u32 s60, s48, 24576
    buffer_load_dwordx4 v[76:79], v52, s[12:15], s60 offen nt
    s_add_u32 s60, s48, 32768
    buffer_load_dwordx4 v[80:83], v52, s[12:15], s60 offen nt
    s_add_u32 s60, s48, 40960
    buffer_load_dwordx4 v[84:87], v52, s[12:15], s60 offen nt
    s_add_u32 s60, s48, 49152
    buffer_load_dwordx4 v[88:91], v52, s[12:15], s60 offen nt
    s_add_u32 s60, s48, 57344
    buffer_load_dwordx4 v[92:95], v52, s[12:15], s60 offen nt
    s_add_u32 s60, s48, 65536
    buffer_load_dwordx4 v[96:99], v52, s[12:15], s60 offen nt
    s_add_u32 s60, s48, 73728
    buffer_load_dwordx4 v[100:103], v52, s[12:15], s60 offen nt
    s_add_u32 s60, s48, 81920
    buffer_load_dwordx4 v[104:107], v52, s[12:15], s60 offen nt
    s_add_u32 s60, s48, 90112
    buffer_load_dwordx4 v[108:111], v52, s[12:15], s60 offen nt
    s_add_u32 s60, s48, 98304
    buffer_load_dwordx4 v[112:115], v52, s[12:15], s60 offen nt
    s_add_u32 s60, s48, 106496
    buffer_load_dwordx4 v[116:119], v52, s[12:15], s60 offen nt
    s_add_u32 s60, s48, 114688
    buffer_load_dwordx4 v[120:123], v52, s[12:15], s60 offen nt
    s_add_u32 s60, s48, 122880
    buffer_load_dwordx4 v[124:127], v52, s[12:15], s60 offen nt
    v_lshrrev_b32 v6, 1, v5
    v_lshrrev_b32 v7, 1, v4
    v_xor_b32 v6, v6, v7
    v_lshlrev_b32 v6, 5, v6
    v_lshl_add_u32 v6, v5, 7, v6
    v_and_b32 v4, 1, v4
    v_lshl_add_u32 v53, v4, 4, v6
    s_lshl_b32 s48, s44, 14
    s_add_u32 s48, s48, 32768
    v_add_u32 v53, s48, v53
    s_cmp_lg_u32 s44, 7
    s_cbranch_scc1 L_bnn0
    buffer_load_dwordx2 v[16:17], v18, s[32:35], 0 offen offset:128 sc0 sc1
L_bnn0:
    s_cmp_ge_u32 s94, 43
    s_cbranch_scc1 L_bnoml
    s_cmp_ge_u32 s44, 2
    s_cbranch_scc1 L_bnoml
    s_lshl_b32 s61, s44, 10
    s_waitcnt vmcnt(16)
    v_lshlrev_b32 v28, 16, v20
    v_and_b32 v29, 0xffff0000, v20
    v_lshlrev_b32 v30, 16, v21
    v_and_b32 v31, 0xffff0000, v21
    v_lshlrev_b32 v32, 16, v22
    v_and_b32 v33, 0xffff0000, v22
    v_lshlrev_b32 v34, 16, v23
    v_and_b32 v35, 0xffff0000, v23
    v_pk_add_f32 v[36:37], v[28:29], v[30:31]
    v_pk_add_f32 v[38:39], v[32:33], v[34:35]
    v_pk_add_f32 v[36:37], v[36:37], v[38:39]
    v_add_f32 v36, v36, v37
    s_nop 1
    v_add_f32_dpp v36, v36, v36 row_ror:8 row_mask:0xf bank_mask:0xf
    s_nop 1
    v_add_f32_dpp v36, v36, v36 row_ror:4 row_mask:0xf bank_mask:0xf
    s_nop 1
    v_add_f32_dpp v36, v36, v36 row_ror:2 row_mask:0xf bank_mask:0xf
    s_nop 1
    v_add_f32_dpp v36, v36, v36 row_ror:1 row_mask:0xf bank_mask:0xf
    v_mov_b32 v38, v36
    s_nop 1
    v_permlane16_swap_b32 v36, v38
    s_nop 1
    v_add_f32 v36, v36, v38
    v_mov_b32 v38, v36
    s_nop 1
    v_permlane32_swap_b32 v36, v38
    s_nop 1
    v_add_f32 v36, v36, v38
    v_mul_f32 v36, 0x3b000000, v36
    v_sub_f32 v38, v28, v36
    v_sub_f32 v39, v29, v36
    v_sub_f32 v40, v30, v36
    v_sub_f32 v41, v31, v36
    v_pk_mul_f32 v[42:43], v[38:39], v[38:39]
    v_pk_fma_f32 v[42:43], v[40:41], v[40:41], v[42:43]
    v_sub_f32 v38, v32, v36
    v_sub_f32 v39, v33, v36
    v_sub_f32 v40, v34, v36
    v_sub_f32 v41, v35, v36
    v_pk_fma_f32 v[42:43], v[38:39], v[38:39], v[42:43]
    v_pk_fma_f32 v[42:43], v[40:41], v[40:41], v[42:43]
    v_add_f32 v38, v42, v43
    s_nop 1
    v_add_f32_dpp v38, v38, v38 row_ror:8 row_mask:0xf bank_mask:0xf
    s_nop 1
    v_add_f32_dpp v38, v38, v38 row_ror:4 row_mask:0xf bank_mask:0xf
    s_nop 1
    v_add_f32_dpp v38, v38, v38 row_ror:2 row_mask:0xf bank_mask:0xf
    s_nop 1
    v_add_f32_dpp v38, v38, v38 row_ror:1 row_mask:0xf bank_mask:0xf
    v_mov_b32 v40, v38
    s_nop 1
    v_permlane16_swap_b32 v38, v40
    s_nop 1
    v_add_f32 v38, v38, v40
    v_mov_b32 v40, v38
    s_nop 1
    v_permlane32_swap_b32 v38, v40
    s_nop 1
    v_add_f32 v38, v38, v40
    v_mul_f32 v38, 0x3b000000, v38
    v_cvt_pk_bf16_f32 v38, v38, v38
    v_and_b32 v38, 0xffff0000, v38
    v_add_f32 v38, 0x3727c5ac, v38
    v_cvt_pk_bf16_f32 v38, v38, v38
    v_and_b32 v38, 0xffff0000, v38
    v_sqrt_f32 v38, v38
    v_cvt_pk_bf16_f32 v36, v36, v36
    v_and_b32 v36, 0xffff0000, v36
    v_cvt_pk_bf16_f32 v38, v38, v38
    v_and_b32 v38, 0xffff0000, v38
    v_rcp_f32 v38, v38
    v_sub_f32 v28, v28, v36
    v_sub_f32 v29, v29, v36
    v_sub_f32 v30, v30, v36
    v_sub_f32 v31, v31, v36
    v_sub_f32 v32, v32, v36
    v_sub_f32 v33, v33, v36
    v_sub_f32 v34, v34, v36
    v_sub_f32 v35, v35, v36
    v_cvt_pk_bf16_f32 v20, v28, v29
    v_cvt_pk_bf16_f32 v21, v30, v31
    v_cvt_pk_bf16_f32 v22, v32, v33
    v_cvt_pk_bf16_f32 v23, v34, v35
    v_lshlrev_b32 v28, 16, v20
    v_and_b32 v29, 0xffff0000, v20
    v_lshlrev_b32 v30, 16, v21
    v_and_b32 v31, 0xffff0000, v21
    v_lshlrev_b32 v32, 16, v22
    v_and_b32 v33, 0xffff0000, v22
    v_lshlrev_b32 v34, 16, v23
    v_and_b32 v35, 0xffff0000, v23
    v_mul_f32 v28, v28, v38
    v_mul_f32 v29, v29, v38
    v_mul_f32 v30, v30, v38
    v_mul_f32 v31, v31, v38
    v_mul_f32 v32, v32, v38
    v_mul_f32 v33, v33, v38
    v_mul_f32 v34, v34, v38
    v_mul_f32 v35, v35, v38
    v_cvt_pk_bf16_f32 v20, v28, v29
    v_cvt_pk_bf16_f32 v21, v30, v31
    v_cvt_pk_bf16_f32 v22, v32, v33
    v_cvt_pk_bf16_f32 v23, v34, v35
    v_add_u32 v36, s61, v19
    ds_write_b128 v36, v[20:23] offset:0
L_bnoml:
    s_lshl_b32 s48, s44, 14
    s_add_u32 s48, s48, 32768
    v_bfe_u32 v4, v3, 1, 2
    v_lshrrev_b32 v5, 1, v2
    v_xor_b32 v4, v4, v5
    v_lshlrev_b32 v4, 5, v4
    v_lshl_add_u32 v4, v3, 7, v4
    v_and_b32 v5, 1, v2
    v_lshl_add_u32 v4, v5, 4, v4
    v_add_u32 v4, s48, v4
    v_xor_b32 v5, 64, v4
    v_lshrrev_b32 v6, 2, v3
    v_lshl_add_u32 v6, v2, 2, v6
    v_bfe_u32 v7, v6, 1, 2
    v_lshlrev_b32 v7, 5, v7
    v_lshl_add_u32 v7, v6, 7, v7
    v_and_b32 v6, 3, v3
    v_lshl_add_u32 v7, v6, 3, v7
    v_add_u32 v224, s48, v7
    v_xor_b32 v225, 32, v224
    v_xor_b32 v226, 64, v224
    v_xor_b32 v227, 0x60, v224
    s_waitcnt vmcnt(12)
    ds_write_b128 v53, v[64:67] offset:0
    ds_write_b128 v53, v[68:71] offset:1024
    ds_write_b128 v53, v[72:75] offset:2048
    ds_write_b128 v53, v[76:79] offset:3072
    ds_read_b128 v[64:67], v4 offset:0
    ds_read_b128 v[68:71], v5 offset:0
    ds_read_b128 v[72:75], v4 offset:2048
    ds_read_b128 v[76:79], v5 offset:2048
    s_waitcnt vmcnt(8)
    ds_write_b128 v53, v[80:83] offset:4096
    ds_write_b128 v53, v[84:87] offset:5120
    ds_write_b128 v53, v[88:91] offset:6144
    ds_write_b128 v53, v[92:95] offset:7168
    ds_read_b128 v[80:83], v4 offset:4096
    ds_read_b128 v[84:87], v5 offset:4096
    ds_read_b128 v[88:91], v4 offset:6144
    ds_read_b128 v[92:95], v5 offset:6144
    s_waitcnt vmcnt(4)
    ds_write_b128 v53, v[96:99] offset:8192
    ds_write_b128 v53, v[100:103] offset:9216
    ds_write_b128 v53, v[104:107] offset:10240
    ds_write_b128 v53, v[108:111] offset:11264
    ds_read_b128 v[96:99], v4 offset:8192
    ds_read_b128 v[100:103], v5 offset:8192
    ds_read_b128 v[104:107], v4 offset:10240
    ds_read_b128 v[108:111], v5 offset:10240
    s_waitcnt vmcnt(0)
    ds_write_b128 v53, v[112:115] offset:12288
    ds_write_b128 v53, v[116:119] offset:13312
    ds_write_b128 v53, v[120:123] offset:14336
    ds_write_b128 v53, v[124:127] offset:15360
    ds_read_b128 v[112:115], v4 offset:12288
    ds_read_b128 v[116:119], v5 offset:12288
    ds_read_b128 v[120:123], v4 offset:14336
    ds_read_b128 v[124:127], v5 offset:14336
    s_waitcnt lgkmcnt(0)
    v_mov_b32 v44, v19
    v_add_u32 v45, s48, v19
    s_lshl_b32 s49, s44, 10
    s_add_u32 s49, s49, 32768
    v_add_u32 v46, s49, v19
    v_add_u32 v47, 0x10000, v46
    v_lshlrev_b32 v49, 5, v3
    s_lshl_b32 s49, s44, 2
    v_add_u32 v48, s49, v49
    s_lshr_b32 s49, s44, 1
    s_lshl_b32 s49, s49, 10
    s_and_b32 s60, s44, 1
    s_lshl_b32 s60, s60, 3
    s_add_u32 s49, s49, s60
    v_add_u32 v50, s49, v19
    v_and_b32 v4, 7, v3
    v_lshlrev_b32 v51, 17, v4
    v_lshl_add_u32 v51, v2, 4, v51
    v_lshrrev_b32 v4, 3, v3
    v_lshl_add_u32 v51, v4, 6, v51
    s_lshl_b32 s48, s51, 1
    s_add_u32 s48, s48, s53
    s_lshl_b32 s48, s48, 15
    s_lshl_b32 s49, s44, 12
    s_add_u32 s48, s48, s49
    s_add_u32 s48, s48, 0
    v_mov_b32 v228, 0x3f803f80
    v_mov_b32 v229, 0x3f803f80
    v_mov_b32 v230, 0x3f803f80
    v_mov_b32 v231, 0x3f803f80
    s_cmp_lg_u32 s44, 7
    s_cbranch_scc1 L_bnn
    s_mov_b32 s50, 0
    s_branch nzf_23
nz_21:
    s_waitcnt vmcnt(0)
nzf_23:
    v_cmp_eq_u32 vcc, 0, v16
    s_cbranch_vccz nzd_22
    s_add_u32 s50, s50, 1
    s_cmp_gt_u32 s50, 200000
    s_cbranch_scc1 nzd_22
    s_sleep 1
    buffer_load_dwordx2 v[16:17], v18, s[32:35], 0 offen offset:128 sc0 sc1
    s_branch nz_21
nzd_22:
    v_and_b32 v12, s47, v16
    v_bfe_u32 v13, v16, 12, 12
    v_alignbit_b32 v4, v17, v16, 24
    v_and_b32 v14, s47, v4
    v_bfe_u32 v15, v17, 4, 12
    ds_write_b64 v18, v[16:17] offset:16384
    s_waitcnt lgkmcnt(0)
L_bnn:
    s_lshl_b32 s49, s52, 11
    s_lshl_b32 s60, s53, 10
    s_add_u32 s49, s49, s60
    s_add_u32 s49, s49, 1572864
    s_cmp_lg_u32 s44, 7
    s_cbranch_scc1 sne_26
    s_mov_b32 s50, s95
sn_24:
    buffer_load_dwordx4 v[20:23], v19, s[28:31], s49 offen sc0 sc1
    s_waitcnt vmcnt(0)
    v_xor_b32 v57, v20, v12
    v_xor_b32 v58, v21, v13
    v_xor_b32 v59, v22, v14
    v_xor_b32 v60, v23, v15
    v_or3_b32 v56, v57, v58, v59
    v_or_b32 v56, v56, v60
    v_and_b32 v56, s47, v56
    v_cmp_eq_u32 vcc, 0, v56
    s_bcnt1_i32_b64 s61, vcc
    s_cmp_ge_u32 s61, 64
    s_cbranch_scc1 snd_25
    s_add_u32 s50, s50, 1
    s_cmp_gt_u32 s50, 200000
    s_cbranch_scc1 snd_25
    s_sleep 2
    s_branch sn_24
snd_25:
sne_26:
    s_barrier
    ds_read_b64 v[16:17], v18 offset:16384
    s_waitcnt lgkmcnt(0)
    v_and_b32 v12, s47, v16
    v_bfe_u32 v13, v16, 12, 12
    v_alignbit_b32 v4, v17, v16, 24
    v_and_b32 v14, s47, v4
    v_bfe_u32 v15, v17, 4, 12
    s_mov_b32 s50, 0
    s_mov_b64 s[92:93], exec
    buffer_load_dwordx4 v[20:23], v44, s[28:31], s48 offen offset:0
    buffer_load_dwordx4 v[24:27], v44, s[28:31], s48 offen offset:1024
    buffer_load_dwordx4 v[28:31], v44, s[28:31], s48 offen offset:2048
    buffer_load_dwordx4 v[32:35], v44, s[28:31], s48 offen offset:3072
    ds_read_b64_tr_b16 v[128:129], v224 offset:0
    ds_read_b64_tr_b16 v[130:131], v224 offset:2048
    ds_read_b64_tr_b16 v[144:145], v225 offset:0
    ds_read_b64_tr_b16 v[146:147], v225 offset:2048
    ds_read_b64_tr_b16 v[160:161], v226 offset:0
    ds_read_b64_tr_b16 v[162:163], v226 offset:2048
    ds_read_b64_tr_b16 v[176:177], v227 offset:0
    ds_read_b64_tr_b16 v[178:179], v227 offset:2048
    ds_read_b64_tr_b16 v[132:133], v224 offset:4096
    ds_read_b64_tr_b16 v[134:135], v224 offset:6144
    ds_read_b64_tr_b16 v[148:149], v225 offset:4096
    ds_read_b64_tr_b16 v[150:151], v225 offset:6144
    ds_read_b64_tr_b16 v[164:165], v226 offset:4096
    ds_read_b64_tr_b16 v[166:167], v226 offset:6144
    ds_read_b64_tr_b16 v[180:181], v227 offset:4096
    ds_read_b64_tr_b16 v[182:183], v227 offset:6144
    ds_read_b64_tr_b16 v[136:137], v224 offset:8192
    ds_read_b64_tr_b16 v[138:139], v224 offset:10240
    ds_read_b64_tr_b16 v[152:153], v225 offset:8192
    ds_read_b64_tr_b16 v[154:155], v225 offset:10240
    ds_read_b64_tr_b16 v[168:169], v226 offset:8192
    ds_read_b64_tr_b16 v[170:171], v226 offset:10240
    ds_read_b64_tr_b16 v[184:185], v227 offset:8192
    ds_read_b64_tr_b16 v[186:187], v227 offset:10240
    ds_read_b64_tr_b16 v[140:141], v224 offset:12288
    ds_read_b64_tr_b16 v[142:143], v224 offset:14336
    ds_read_b64_tr_b16 v[156:157], v225 offset:12288
    ds_read_b64_tr_b16 v[158:159], v225 offset:14336
    ds_read_b64_tr_b16 v[172:173], v226 offset:12288
    ds_read_b64_tr_b16 v[174:175], v226 offset:14336
    ds_read_b64_tr_b16 v[188:189], v227 offset:12288
    ds_read_b64_tr_b16 v[190:191], v227 offset:14336
    s_branch plf_29
pl_27:
    buffer_load_dwordx4 v[20:23], v44, s[28:31], s48 offen offset:0 sc0 sc1
    buffer_load_dwordx4 v[24:27], v44, s[28:31], s48 offen offset:1024 sc0 sc1
    buffer_load_dwordx4 v[28:31], v44, s[28:31], s48 offen offset:2048 sc0 sc1
    buffer_load_dwordx4 v[32:35], v44, s[28:31], s48 offen offset:3072 sc0 sc1
plf_29:
    s_waitcnt vmcnt(0)
    v_xor_b32 v57, v20, v12
    v_xor_b32 v58, v21, v13
    v_xor_b32 v59, v22, v14
    v_xor_b32 v60, v23, v15
    v_or3_b32 v56, v57, v58, v59
    v_or_b32 v56, v56, v60
    v_xor_b32 v57, v24, v12
    v_xor_b32 v58, v25, v13
    v_xor_b32 v59, v26, v14
    v_xor_b32 v60, v27, v15
    v_or3_b32 v56, v56, v57, v58
    v_or3_b32 v56, v56, v59, v60
    v_xor_b32 v57, v28, v12
    v_xor_b32 v58, v29, v13
    v_xor_b32 v59, v30, v14
    v_xor_b32 v60, v31, v15
    v_or3_b32 v56, v56, v57, v58
    v_or3_b32 v56, v56, v59, v60
    v_xor_b32 v57, v32, v12
    v_xor_b32 v58, v33, v13
    v_xor_b32 v59, v34, v14
    v_xor_b32 v60, v35, v15
    v_or3_b32 v56, v56, v57, v58
    v_or3_b32 v56, v56, v59, v60
    v_and_b32 v56, s47, v56
    v_cmp_ne_u32 vcc, 0, v56
    s_cbranch_vccz pld_28
    s_mov_b64 exec, vcc
    s_add_u32 s50, s50, 1
    s_cmp_gt_u32 s50, 200000
    s_cbranch_scc0 pl_27
pld_28:
    s_mov_b64 exec, s[92:93]
    v_perm_b32 v36, v21, v20, s56
    v_perm_b32 v37, v23, v22, s56
    v_perm_b32 v38, v25, v24, s56
    v_perm_b32 v39, v27, v26, s56
    v_perm_b32 v40, v29, v28, s56
    v_perm_b32 v41, v31, v30, s56
    v_perm_b32 v42, v33, v32, s56
    v_perm_b32 v43, v35, v34, s56
    s_nop 1
    v_mfma_f32_16x16x32_bf16 v[192:195], v[64:67], v[36:39], 0
    v_mfma_f32_16x16x32_bf16 v[196:199], v[72:75], v[36:39], 0
    v_mfma_f32_16x16x32_bf16 v[200:203], v[80:83], v[36:39], 0
    v_mfma_f32_16x16x32_bf16 v[204:207], v[88:91], v[36:39], 0
    v_mfma_f32_16x16x32_bf16 v[208:211], v[96:99], v[36:39], 0
    v_mfma_f32_16x16x32_bf16 v[212:215], v[104:107], v[36:39], 0
    v_mfma_f32_16x16x32_bf16 v[216:219], v[112:115], v[36:39], 0
    v_mfma_f32_16x16x32_bf16 v[220:223], v[120:123], v[36:39], 0
    v_mfma_f32_16x16x32_bf16 v[192:195], v[68:71], v[40:43], v[192:195]
    v_mfma_f32_16x16x32_bf16 v[196:199], v[76:79], v[40:43], v[196:199]
    v_mfma_f32_16x16x32_bf16 v[200:203], v[84:87], v[40:43], v[200:203]
    v_mfma_f32_16x16x32_bf16 v[204:207], v[92:95], v[40:43], v[204:207]
    v_mfma_f32_16x16x32_bf16 v[208:211], v[100:103], v[40:43], v[208:211]
    v_mfma_f32_16x16x32_bf16 v[212:215], v[108:111], v[40:43], v[212:215]
    v_mfma_f32_16x16x32_bf16 v[216:219], v[116:119], v[40:43], v[216:219]
    v_mfma_f32_16x16x32_bf16 v[220:223], v[124:127], v[40:43], v[220:223]
    s_nop 7
    s_nop 2
    ds_write_b128 v45, v[192:195] offset:0
    ds_write_b128 v45, v[196:199] offset:1024
    ds_write_b128 v45, v[200:203] offset:2048
    ds_write_b128 v45, v[204:207] offset:3072
    ds_write_b128 v45, v[208:211] offset:4096
    ds_write_b128 v45, v[212:215] offset:5120
    ds_write_b128 v45, v[216:219] offset:6144
    ds_write_b128 v45, v[220:223] offset:7168
    s_and_b32 s48, s54, 7
    s_lshr_b32 s49, s54, 3
    s_cmp_eq_u32 s44, 4
    s_cbranch_scc1 L_bwarm1
    s_cmp_lg_u32 s44, 5
    s_cbranch_scc1 L_bwarmd
    s_mul_i32 s48, s48, 196608
    s_mul_i32 s49, s49, 12288
    s_add_u32 s48, s48, s49
    v_lshlrev_b32 v113, 7, v1
    buffer_load_dword v112, v113, s[20:23], s48 offen
    s_add_u32 s48, s48, 8192
    s_mov_b32 exec_hi, 0
    buffer_load_dword v113, v113, s[20:23], s48 offen
    s_mov_b64 exec, -1
    s_branch L_bwarmd
L_bwarm1:
    s_mul_i32 s48, s48, 384
    s_mul_i32 s49, s49, 88064
    s_add_u32 s48, s48, s49
    s_movk_i32 s49, 2752
    v_lshrrev_b32 v112, 2, v1
    v_mul_lo_u32 v112, v112, s49
    v_and_b32 v113, 3, v1
    v_lshlrev_b32 v113, 7, v113
    v_min_u32 v113, 380, v113
    v_add_u32 v113, v112, v113
    buffer_load_dword v112, v113, s[16:19], s48 offen
    s_add_u32 s48, s48, 44032
    buffer_load_dword v113, v113, s[16:19], s48 offen
L_bwarmd:
    s_waitcnt lgkmcnt(0)
    s_barrier
    ds_read_b128 v[64:67], v46 offset:0
    ds_read_b128 v[68:71], v46 offset:16384
    ds_read_b128 v[72:75], v46 offset:32768
    ds_read_b128 v[76:79], v46 offset:49152
    ds_read_b128 v[80:83], v47 offset:0
    ds_read_b128 v[84:87], v47 offset:16384
    ds_read_b128 v[88:91], v47 offset:32768
    ds_read_b128 v[92:95], v47 offset:49152
    s_waitcnt lgkmcnt(0)
    v_add_f32 v64, v64, v68
    v_add_f32 v72, v72, v76
    v_add_f32 v80, v80, v84
    v_add_f32 v88, v88, v92
    v_add_f32 v65, v65, v69
    v_add_f32 v73, v73, v77
    v_add_f32 v81, v81, v85
    v_add_f32 v89, v89, v93
    v_add_f32 v66, v66, v70
    v_add_f32 v74, v74, v78
    v_add_f32 v82, v82, v86
    v_add_f32 v90, v90, v94
    v_add_f32 v67, v67, v71
    v_add_f32 v75, v75, v79
    v_add_f32 v83, v83, v87
    v_add_f32 v91, v91, v95
    v_add_f32 v64, v64, v72
    v_add_f32 v80, v80, v88
    v_add_f32 v65, v65, v73
    v_add_f32 v81, v81, v89
    v_add_f32 v66, v66, v74
    v_add_f32 v82, v82, v90
    v_add_f32 v67, v67, v75
    v_add_f32 v83, v83, v91
    v_add_f32 v20, v64, v80
    v_add_f32 v21, v65, v81
    v_add_f32 v22, v66, v82
    v_add_f32 v23, v67, v83
    v_mul_f32 v20, 0x3e0293ee, v20
    v_mul_f32 v21, 0x3e0293ee, v21
    v_mul_f32 v22, 0x3e0293ee, v22
    v_mul_f32 v23, 0x3e0293ee, v23
    v_max_f32 v24, v20, v21
    v_max3_f32 v24, v24, v22, v23
    v_mov_b32 v25, v24
    s_nop 1
    v_permlane16_swap_b32 v24, v25
    s_nop 1
    v_max_f32 v24, v24, v25
    v_mov_b32 v25, v24
    s_nop 1
    v_permlane32_swap_b32 v24, v25
    s_nop 1
    v_max_f32 v24, v24, v25
    ds_write_b32 v48, v24 offset:4096
    s_waitcnt lgkmcnt(0)
    s_barrier
    ds_read_b128 v[24:27], v49 offset:4096
    ds_read_b128 v[28:31], v49 offset:4112
    s_waitcnt lgkmcnt(0)
    v_max3_f32 v24, v24, v25, v26
    v_max3_f32 v28, v28, v29, v30
    v_max3_f32 v24, v24, v27, v31
    v_max_f32 v24, v24, v28
    v_and_b32 v24, s55, v24
    v_sub_f32 v20, v20, v24
    v_sub_f32 v21, v21, v24
    v_sub_f32 v22, v22, v24
    v_sub_f32 v23, v23, v24
    v_exp_f32 v20, v20
    v_exp_f32 v21, v21
    v_exp_f32 v22, v22
    v_exp_f32 v23, v23
    s_nop 0
    v_cvt_pk_bf16_f32 v20, v20, v21
    v_cvt_pk_bf16_f32 v21, v22, v23
    ds_write_b64 v50, v[20:21] offset:8192
    s_waitcnt lgkmcnt(0)
    s_barrier
    ds_read_b128 v[96:99], v19 offset:8192
    ds_read_b128 v[100:103], v19 offset:9216
    ds_read_b128 v[104:107], v19 offset:10240
    ds_read_b128 v[108:111], v19 offset:11264
    s_lshl_b32 s48, s53, 21
    s_lshr_b32 s49, s44, 1
    s_lshl_b32 s49, s49, 15
    s_add_u32 s48, s48, s49
    s_lshl_b32 s49, s52, 9
    s_add_u32 s48, s48, s49
    s_and_b32 s49, s44, 1
    s_lshl_b32 s49, s49, 8
    s_add_u32 s48, s48, s49
    s_add_u32 s48, s48, 2097152
    s_add_u32 s49, s48, 0x100000
    s_waitcnt lgkmcnt(3)
    v_mfma_f32_16x16x32_bf16 v[192:195], v[128:131], v[96:99], 0
    v_mfma_f32_16x16x32_bf16 v[196:199], v[144:147], v[96:99], 0
    v_mfma_f32_16x16x32_bf16 v[200:203], v[160:163], v[96:99], 0
    v_mfma_f32_16x16x32_bf16 v[204:207], v[176:179], v[96:99], 0
    v_mfma_f32_16x16x32_bf16 v[208:211], v[228:231], v[96:99], 0
    s_waitcnt lgkmcnt(2)
    v_mfma_f32_16x16x32_bf16 v[192:195], v[132:135], v[100:103], v[192:195]
    v_mfma_f32_16x16x32_bf16 v[196:199], v[148:151], v[100:103], v[196:199]
    v_mfma_f32_16x16x32_bf16 v[200:203], v[164:167], v[100:103], v[200:203]
    v_mfma_f32_16x16x32_bf16 v[204:207], v[180:183], v[100:103], v[204:207]
    v_mfma_f32_16x16x32_bf16 v[208:211], v[228:231], v[100:103], v[208:211]
    s_waitcnt lgkmcnt(1)
    v_mfma_f32_16x16x32_bf16 v[192:195], v[136:139], v[104:107], v[192:195]
    v_mfma_f32_16x16x32_bf16 v[196:199], v[152:155], v[104:107], v[196:199]
    v_mfma_f32_16x16x32_bf16 v[200:203], v[168:171], v[104:107], v[200:203]
    v_mfma_f32_16x16x32_bf16 v[204:207], v[184:187], v[104:107], v[204:207]
    v_mfma_f32_16x16x32_bf16 v[208:211], v[228:231], v[104:107], v[208:211]
    s_waitcnt lgkmcnt(0)
    v_mfma_f32_16x16x32_bf16 v[192:195], v[140:143], v[108:111], v[192:195]
    v_mfma_f32_16x16x32_bf16 v[196:199], v[156:159], v[108:111], v[196:199]
    v_mfma_f32_16x16x32_bf16 v[200:203], v[172:175], v[108:111], v[200:203]
    v_mfma_f32_16x16x32_bf16 v[204:207], v[188:191], v[108:111], v[204:207]
    v_mfma_f32_16x16x32_bf16 v[208:211], v[228:231], v[108:111], v[208:211]
    s_nop 7
    s_nop 2
    v_bfi_b32 v64, s47, v12, v192
    v_bfi_b32 v65, s47, v13, v193
    v_bfi_b32 v66, s47, v14, v194
    v_bfi_b32 v67, s47, v15, v195
    v_bfi_b32 v68, s47, v12, v196
    v_bfi_b32 v69, s47, v13, v197
    v_bfi_b32 v70, s47, v14, v198
    v_bfi_b32 v71, s47, v15, v199
    v_mov_b32 v80, v64
    v_mov_b32 v81, v65
    v_mov_b32 v82, v66
    v_mov_b32 v83, v67
    v_mov_b32_dpp v64, v68 row_ror:8 row_mask:0xf bank_mask:0xc
    v_mov_b32_dpp v65, v69 row_ror:8 row_mask:0xf bank_mask:0xc
    v_mov_b32_dpp v66, v70 row_ror:8 row_mask:0xf bank_mask:0xc
    v_mov_b32_dpp v67, v71 row_ror:8 row_mask:0xf bank_mask:0xc
    v_mov_b32_dpp v68, v80 row_ror:8 row_mask:0xf bank_mask:0x3
    v_mov_b32_dpp v69, v81 row_ror:8 row_mask:0xf bank_mask:0x3
    v_mov_b32_dpp v70, v82 row_ror:8 row_mask:0xf bank_mask:0x3
    v_mov_b32_dpp v71, v83 row_ror:8 row_mask:0xf bank_mask:0x3
    buffer_store_dwordx4 v[64:67], v51, s[28:31], s48 offen offset:0 sc0 sc1
    buffer_store_dwordx4 v[68:71], v51, s[28:31], s49 offen offset:0 sc0 sc1
    v_bfi_b32 v72, s47, v12, v200
    v_bfi_b32 v73, s47, v13, v201
    v_bfi_b32 v74, s47, v14, v202
    v_bfi_b32 v75, s47, v15, v203
    v_bfi_b32 v76, s47, v12, v204
    v_bfi_b32 v77, s47, v13, v205
    v_bfi_b32 v78, s47, v14, v206
    v_bfi_b32 v79, s47, v15, v207
    v_mov_b32 v80, v72
    v_mov_b32 v81, v73
    v_mov_b32 v82, v74
    v_mov_b32 v83, v75
    v_mov_b32_dpp v72, v76 row_ror:8 row_mask:0xf bank_mask:0xc
    v_mov_b32_dpp v73, v77 row_ror:8 row_mask:0xf bank_mask:0xc
    v_mov_b32_dpp v74, v78 row_ror:8 row_mask:0xf bank_mask:0xc
    v_mov_b32_dpp v75, v79 row_ror:8 row_mask:0xf bank_mask:0xc
    v_mov_b32_dpp v76, v80 row_ror:8 row_mask:0xf bank_mask:0x3
    v_mov_b32_dpp v77, v81 row_ror:8 row_mask:0xf bank_mask:0x3
    v_mov_b32_dpp v78, v82 row_ror:8 row_mask:0xf bank_mask:0x3
    v_mov_b32_dpp v79, v83 row_ror:8 row_mask:0xf bank_mask:0x3
    buffer_store_dwordx4 v[72:75], v51, s[28:31], s48 offen offset:128 sc0 sc1
    buffer_store_dwordx4 v[76:79], v51, s[28:31], s49 offen offset:128 sc0 sc1
    s_cmp_lg_u32 s44, 0
    s_cbranch_scc1 L_noml
    v_mov_b32 v25, v208
    v_mov_b32 v26, 0
    v_mov_b32 v27, 0
    v_bfi_b32 v24, s47, v12, v24
    v_bfi_b32 v25, s47, v13, v25
    v_bfi_b32 v26, s47, v14, v26
    v_bfi_b32 v27, s47, v15, v27
    v_lshlrev_b32 v4, 10, v3
    s_lshl_b32 s48, s53, 14
    s_lshl_b32 s49, s52, 4
    s_add_u32 s48, s48, s49
    s_add_u32 s48, s48, 262144
    v_cmp_gt_u32 vcc, 16, v1
    s_and_saveexec_b64 s[58:59], vcc
    buffer_store_dwordx4 v[24:27], v4, s[28:31], s48 offen sc0 sc1
    s_mov_b64 exec, s[58:59]
L_noml:
    s_cmp_ge_u32 s94, 43
    s_cbranch_scc1 L_bnomc
    s_barrier
    s_movk_i32 s48, 2752
    v_lshrrev_b32 v6, 2, v1
    v_mul_lo_u32 v5, v6, s48
    v_and_b32 v4, 3, v1
    v_lshl_add_u32 v5, v4, 4, v5
    v_lshlrev_b32 v6, 12, v2
    v_lshl_add_u32 v6, v3, 4, v6
    s_mul_i32 s48, s44, 176128
    s_lshl_b32 s49, s94, 6
    s_add_u32 s48, s48, s49
    s_add_u32 s60, s48, 0
    buffer_load_dwordx4 v[112:115], v5, s[16:19], s60 offen nt
    s_add_u32 s60, s48, 44032
    buffer_load_dwordx4 v[116:119], v5, s[16:19], s60 offen nt
    s_add_u32 s60, s48, 88064
    buffer_load_dwordx4 v[120:123], v5, s[16:19], s60 offen nt
    s_add_u32 s60, s48, 132096
    buffer_load_dwordx4 v[124:127], v5, s[16:19], s60 offen nt
    s_lshr_b32 s61, s44, 2
    s_lshl_b32 s48, s94, 15
    s_lshl_b32 s60, s61, 14
    s_add_u32 s48, s48, s60
    s_and_b32 s60, s44, 3
    s_lshl_b32 s60, s60, 8
    s_add_u32 s48, s48, s60
    s_lshl_b32 s61, s61, 5
    s_add_u32 s49, s49, s61
    v_lshlrev_b32 v4, 3, v2
    buffer_load_dwordx4 v[232:235], v6, s[20:23], s48 offen offset:0 nt
    buffer_load_dwordx4 v[236:239], v6, s[20:23], s48 offen offset:1024 nt
    buffer_load_dwordx4 v[240:243], v6, s[20:23], s48 offen offset:2048 nt
    buffer_load_dwordx4 v[244:247], v6, s[20:23], s48 offen offset:3072 nt
    buffer_load_dwordx2 v[248:249], v4, s[24:27], s49 offen
    s_waitcnt vmcnt(5)
    s_lshl_b32 s49, s44, 14
    s_add_u32 s49, s49, 40960
    v_add_u32 v4, s49, v19
    ds_write_b128 v4, v[112:115] offset:0
    ds_write_b128 v4, v[116:119] offset:1024
    ds_write_b128 v4, v[120:123] offset:2048
    ds_write_b128 v4, v[124:127] offset:3072
    s_lshl_b32 s48, s44, 14
    s_add_u32 s48, s48, 40960
    v_lshrrev_b32 v4, 2, v3
    v_lshl_add_u32 v4, v2, 3, v4
    v_lshlrev_b32 v4, 6, v4
    v_and_b32 v5, 3, v3
    v_lshl_add_u32 v4, v5, 3, v4
    v_add_u32 v55, s48, v4
    v_and_b32 v4, 1, v3
    v_lshlrev_b32 v4, 10, v4
    v_lshl_add_u32 v4, v2, 4, v4
    s_lshl_b32 s48, s44, 7
    v_add_u32 v50, s48, v4
    s_lshl_b32 s48, s44, 8
    v_lshlrev_b32 v5, 2, v3
    v_add_u32 v51, s48, v5
    v_lshrrev_b32 v6, 3, v3
    v_lshlrev_b32 v6, 7, v6
    v_lshl_add_u32 v6, v2, 4, v6
    s_lshr_b32 s48, s44, 2
    s_lshl_b32 s48, s48, 6
    v_add_u32 v6, s48, v6
    s_waitcnt lgkmcnt(0)
    ds_read_b64_tr_b16 v[112:113], v55 offset:0
    ds_read_b64_tr_b16 v[114:115], v55 offset:256
    ds_read_b64_tr_b16 v[116:117], v55 offset:2048
    ds_read_b64_tr_b16 v[118:119], v55 offset:2304
    ds_read_b64_tr_b16 v[120:121], v55 offset:32
    ds_read_b64_tr_b16 v[122:123], v55 offset:288
    ds_read_b64_tr_b16 v[124:125], v55 offset:2080
    ds_read_b64_tr_b16 v[126:127], v55 offset:2336
    ds_read_b128 v[28:31], v50 offset:0
    ds_read_b128 v[32:35], v50 offset:64
    s_waitcnt lgkmcnt(0)
    v_mfma_f32_16x16x32_bf16 v[56:59], v[28:31], v[112:115], 0
    v_mfma_f32_16x16x32_bf16 v[60:63], v[28:31], v[120:123], 0
    v_mfma_f32_16x16x32_bf16 v[56:59], v[32:35], v[116:119], v[56:59]
    v_mfma_f32_16x16x32_bf16 v[60:63], v[32:35], v[124:127], v[60:63]
    s_nop 7
    s_nop 2
    ds_write_b32 v51, v56 offset:2048
    ds_write_b32 v51, v57 offset:2176
    ds_write_b32 v51, v60 offset:2112
    ds_write_b32 v51, v61 offset:2240
    s_waitcnt lgkmcnt(0)
    s_barrier
    ds_read_b128 v[20:23], v6 offset:2048
    ds_read_b128 v[24:27], v6 offset:2304
    ds_read_b128 v[28:31], v6 offset:2560
    ds_read_b128 v[32:35], v6 offset:2816
    ds_read_b128 v[36:39], v6 offset:3072
    ds_read_b128 v[40:43], v6 offset:3328
    ds_read_b128 v[44:47], v6 offset:3584
    ds_read_b128 v[128:131], v6 offset:3840
    s_waitcnt lgkmcnt(0)
    v_add_f32 v20, v20, v24
    v_add_f32 v28, v28, v32
    v_add_f32 v36, v36, v40
    v_add_f32 v44, v44, v128
    v_add_f32 v21, v21, v25
    v_add_f32 v29, v29, v33
    v_add_f32 v37, v37, v41
    v_add_f32 v45, v45, v129
    v_add_f32 v22, v22, v26
    v_add_f32 v30, v30, v34
    v_add_f32 v38, v38, v42
    v_add_f32 v46, v46, v130
    v_add_f32 v23, v23, v27
    v_add_f32 v31, v31, v35
    v_add_f32 v39, v39, v43
    v_add_f32 v47, v47, v131
    v_add_f32 v20, v20, v28
    v_add_f32 v36, v36, v44
    v_add_f32 v21, v21, v29
    v_add_f32 v37, v37, v45
    v_add_f32 v22, v22, v30
    v_add_f32 v38, v38, v46
    v_add_f32 v23, v23, v31
    v_add_f32 v39, v39, v47
    v_add_f32 v56, v20, v36
    v_add_f32 v57, v21, v37
    v_add_f32 v58, v22, v38
    v_add_f32 v59, v23, v39
    s_waitcnt vmcnt(0)
    v_lshlrev_b32 v20, 16, v248
    v_and_b32 v21, 0xffff0000, v248
    v_lshlrev_b32 v22, 16, v249
    v_and_b32 v23, 0xffff0000, v249
    v_cvt_pk_bf16_f32 v56, v56, v56
    v_and_b32 v56, 0xffff0000, v56
    v_cvt_pk_bf16_f32 v57, v57, v57
    v_and_b32 v57, 0xffff0000, v57
    v_cvt_pk_bf16_f32 v58, v58, v58
    v_and_b32 v58, 0xffff0000, v58
    v_cvt_pk_bf16_f32 v59, v59, v59
    v_and_b32 v59, 0xffff0000, v59
    v_add_f32 v56, v56, v20
    v_add_f32 v57, v57, v21
    v_add_f32 v58, v58, v22
    v_add_f32 v59, v59, v23
    v_cvt_pk_bf16_f32 v56, v56, v56
    v_and_b32 v56, 0xffff0000, v56
    v_cvt_pk_bf16_f32 v57, v57, v57
    v_and_b32 v57, 0xffff0000, v57
    v_cvt_pk_bf16_f32 v58, v58, v58
    v_and_b32 v58, 0xffff0000, v58
    v_cvt_pk_bf16_f32 v59, v59, v59
    v_and_b32 v59, 0xffff0000, v59
    v_mul_f32 v20, v56, v56
    v_mul_f32 v20, 0x3d372713, v20
    v_fma_f32 v20, v20, v56, v56
    v_mul_f32 v20, 0xc0135761, v20
    v_exp_f32 v20, v20
    v_mul_f32 v21, v57, v57
    v_mul_f32 v21, 0x3d372713, v21
    v_fma_f32 v21, v21, v57, v57
    v_mul_f32 v21, 0xc0135761, v21
    v_exp_f32 v21, v21
    v_mul_f32 v22, v58, v58
    v_mul_f32 v22, 0x3d372713, v22
    v_fma_f32 v22, v22, v58, v58
    v_mul_f32 v22, 0xc0135761, v22
    v_exp_f32 v22, v22
    v_mul_f32 v23, v59, v59
    v_mul_f32 v23, 0x3d372713, v23
    v_fma_f32 v23, v23, v59, v59
    v_mul_f32 v23, 0xc0135761, v23
    v_exp_f32 v23, v23
    v_add_f32 v20, 1.0, v20
    v_add_f32 v21, 1.0, v21
    v_add_f32 v22, 1.0, v22
    v_add_f32 v23, 1.0, v23
    v_rcp_f32 v20, v20
    v_rcp_f32 v21, v21
    v_rcp_f32 v22, v22
    v_rcp_f32 v23, v23
    s_nop 0
    v_mul_f32 v56, v56, v20
    v_mul_f32 v57, v57, v21
    v_mul_f32 v58, v58, v22
    v_mul_f32 v59, v59, v23
    v_cvt_pk_bf16_f32 v56, v56, v56
    v_cvt_pk_bf16_f32 v57, v57, v57
    v_cvt_pk_bf16_f32 v58, v58, v58
    v_cvt_pk_bf16_f32 v59, v59, v59
    v_and_b32 v28, v56, v8
    v_and_b32 v29, v56, v9
    v_and_b32 v30, v56, v10
    v_and_b32 v31, v56, v11
    s_nop 1
    v_mfma_f32_16x16x32_bf16 v[60:63], v[28:31], v[232:235], 0
    v_and_b32 v32, v57, v8
    v_and_b32 v33, v57, v9
    v_and_b32 v34, v57, v10
    v_and_b32 v35, v57, v11
    s_nop 1
    v_mfma_f32_16x16x32_bf16 v[60:63], v[32:35], v[236:239], v[60:63]
    v_and_b32 v36, v58, v8
    v_and_b32 v37, v58, v9
    v_and_b32 v38, v58, v10
    v_and_b32 v39, v58, v11
    s_nop 1
    v_mfma_f32_16x16x32_bf16 v[60:63], v[36:39], v[240:243], v[60:63]
    v_and_b32 v40, v59, v8
    v_and_b32 v41, v59, v9
    v_and_b32 v42, v59, v10
    v_and_b32 v43, v59, v11
    s_nop 1
    v_mfma_f32_16x16x32_bf16 v[60:63], v[40:43], v[244:247], v[60:63]
    v_lshrrev_b32 v4, 1, v2
    v_lshlrev_b32 v4, 5, v4
    v_lshrrev_b32 v5, 1, v3
    v_add_u32 v4, v4, v5
    v_lshlrev_b32 v4, 13, v4
    v_and_b32 v5, 1, v3
    v_lshl_add_u32 v4, v5, 5, v4
    v_and_b32 v5, 1, v2
    v_lshl_add_u32 v4, v5, 4, v4
    s_lshl_b32 s48, s94, 1
    s_lshr_b32 s49, s44, 2
    s_add_u32 s48, s48, s49
    s_lshl_b32 s48, s48, 6
    s_and_b32 s49, s44, 3
    s_lshl_b32 s49, s49, 16
    s_add_u32 s48, s48, s49
    s_add_u32 s48, s48, 1048576
    s_nop 2
    v_bfi_b32 v56, s47, v12, v60
    v_bfi_b32 v57, s47, v13, v61
    v_bfi_b32 v58, s47, v14, v62
    v_bfi_b32 v59, s47, v15, v63
    buffer_store_dwordx4 v[56:59], v4, s[28:31], s48 offen sc0 sc1
L_bnomc:
    s_cmp_lt_u32 s54, 64
    s_cbranch_scc1 L_endB
    s_sub_u32 s57, s54, 64
    v_lshlrev_b32 v4, 4, v0
    s_lshl_b32 s48, s57, 13
    s_add_u32 s49, s48, 524288
    s_add_u32 s48, s48, 1048576
    v_lshlrev_b32 v5, 1, v3
    s_lshl_b32 s60, s57, 5
    s_and_b32 s61, s60, 1023
    buffer_load_ushort v40, v5, s[8:11], s60 offen
    buffer_load_ushort v41, v5, s[40:43], s61 offen
    v_and_b32 v6, 3, v1
    v_lshlrev_b32 v6, 4, v6
    s_lshl_b32 s61, s44, 6
    v_add_u32 v6, s61, v6
    v_lshlrev_b32 v7, 2, v3
    v_mov_b32 v20, 0
    v_mov_b32 v21, 0
    v_mov_b32 v22, 0
    v_mov_b32 v23, 0
    s_cmp_ge_u32 s44, 6
    s_cbranch_scc1 L_noy
    v_cmp_gt_u32 vcc, 344, v0
    s_and_saveexec_b64 s[58:59], vcc
    s_mov_b32 s50, 0
    s_mov_b64 s[92:93], exec
pl_30:
    buffer_load_dwordx4 v[20:23], v4, s[28:31], s48 offen sc0 sc1
plf_32:
    s_waitcnt vmcnt(0)
    v_xor_b32 v57, v20, v12
    v_xor_b32 v58, v21, v13
    v_xor_b32 v59, v22, v14
    v_xor_b32 v60, v23, v15
    v_or3_b32 v56, v57, v58, v59
    v_or_b32 v56, v56, v60
    v_and_b32 v56, s47, v56
    v_cmp_ne_u32 vcc, 0, v56
    s_cbranch_vccz pld_31
    s_mov_b64 exec, vcc
    s_add_u32 s50, s50, 1
    s_cmp_gt_u32 s50, 200000
    s_cbranch_scc0 pl_30
pld_31:
    s_mov_b64 exec, s[92:93]
    v_and_b32 v20, s55, v20
    v_and_b32 v21, s55, v21
    v_and_b32 v22, s55, v22
    v_and_b32 v23, s55, v23
    s_mov_b64 exec, s[58:59]
L_noy:
    buffer_load_dwordx4 v[32:35], v4, s[28:31], s49 offen sc0 sc1
    s_nop 1
    v_add_f32_dpp v20, v20, v20 row_ror:8 row_mask:0xf bank_mask:0xf
    s_nop 1
    v_add_f32_dpp v20, v20, v20 row_ror:4 row_mask:0xf bank_mask:0xf
    s_nop 1
    v_add_f32_dpp v21, v21, v21 row_ror:8 row_mask:0xf bank_mask:0xf
    s_nop 1
    v_add_f32_dpp v21, v21, v21 row_ror:4 row_mask:0xf bank_mask:0xf
    s_nop 1
    v_add_f32_dpp v22, v22, v22 row_ror:8 row_mask:0xf bank_mask:0xf
    s_nop 1
    v_add_f32_dpp v22, v22, v22 row_ror:4 row_mask:0xf bank_mask:0xf
    s_nop 1
    v_add_f32_dpp v23, v23, v23 row_ror:8 row_mask:0xf bank_mask:0xf
    s_nop 1
    v_add_f32_dpp v23, v23, v23 row_ror:4 row_mask:0xf bank_mask:0xf
    v_mov_b32 v24, v20
    s_nop 1
    v_permlane16_swap_b32 v20, v24
    s_nop 1
    v_add_f32 v20, v20, v24
    v_mov_b32 v24, v20
    s_nop 1
    v_permlane32_swap_b32 v20, v24
    s_nop 1
    v_add_f32 v20, v20, v24
    v_mov_b32 v24, v21
    s_nop 1
    v_permlane16_swap_b32 v21, v24
    s_nop 1
    v_add_f32 v21, v21, v24
    v_mov_b32 v24, v21
    s_nop 1
    v_permlane32_swap_b32 v21, v24
    s_nop 1
    v_add_f32 v21, v21, v24
    v_mov_b32 v24, v22
    s_nop 1
    v_permlane16_swap_b32 v22, v24
    s_nop 1
    v_add_f32 v22, v22, v24
    v_mov_b32 v24, v22
    s_nop 1
    v_permlane32_swap_b32 v22, v24
    s_nop 1
    v_add_f32 v22, v22, v24
    v_mov_b32 v24, v23
    s_nop 1
    v_permlane16_swap_b32 v23, v24
    s_nop 1
    v_add_f32 v23, v23, v24
    v_mov_b32 v24, v23
    s_nop 1
    v_permlane32_swap_b32 v23, v24
    s_nop 1
    v_add_f32 v23, v23, v24
    ds_write_b128 v6, v[20:23] offset:12288
    s_waitcnt lgkmcnt(0)
    s_barrier
    ds_read_b32 v24, v7 offset:12288
    ds_read_b32 v25, v7 offset:12352
    ds_read_b32 v26, v7 offset:12416
    ds_read_b32 v27, v7 offset:12480
    ds_read_b32 v28, v7 offset:12544
    ds_read_b32 v29, v7 offset:12608
    ds_read_b32 v30, v7 offset:12672
    ds_read_b32 v31, v7 offset:12736
    s_waitcnt lgkmcnt(0)
    v_add_f32 v24, v24, v25
    v_add_f32 v26, v26, v27
    v_add_f32 v28, v28, v29
    v_add_f32 v30, v30, v31
    v_add_f32 v24, v24, v26
    v_add_f32 v28, v28, v30
    v_add_f32 v24, v24, v28
    v_cvt_pk_bf16_f32 v24, v24, v24
    v_and_b32 v24, 0xffff0000, v24
    s_waitcnt vmcnt(1)
    v_lshlrev_b32 v41, 16, v41
    v_lshlrev_b32 v40, 16, v40
    v_add_f32 v24, v24, v41
    v_cvt_pk_bf16_f32 v24, v24, v24
    v_and_b32 v24, 0xffff0000, v24
    v_mul_f32 v25, 0xbfb8aa3b, v24
    v_exp_f32 v25, v25
    s_nop 0
    v_add_f32 v25, 1.0, v25
    v_rcp_f32 v25, v25
    s_nop 0
    v_mul_f32 v42, v24, v25
    v_cvt_pk_bf16_f32 v42, v42, v42
    v_and_b32 v42, 0xffff0000, v42
    s_mov_b32 s50, 0
    s_mov_b64 s[92:93], exec
    s_nop 0
    s_branch plf_35
pl_33:
    buffer_load_dwordx4 v[32:35], v4, s[28:31], s49 offen sc0 sc1
plf_35:
    s_waitcnt vmcnt(0)
    v_xor_b32 v57, v32, v12
    v_xor_b32 v58, v33, v13
    v_xor_b32 v59, v34, v14
    v_xor_b32 v60, v35, v15
    v_or3_b32 v56, v57, v58, v59
    v_or_b32 v56, v56, v60
    v_and_b32 v56, s47, v56
    v_cmp_ne_u32 vcc, 0, v56
    s_cbranch_vccz pld_34
    s_mov_b64 exec, vcc
    s_add_u32 s50, s50, 1
    s_cmp_gt_u32 s50, 200000
    s_cbranch_scc0 pl_33
pld_34:
    s_mov_b64 exec, s[92:93]
    v_and_b32 v20, s55, v32
    v_and_b32 v21, s55, v33
    v_and_b32 v22, s55, v34
    v_and_b32 v23, s55, v35
    s_nop 1
    v_add_f32_dpp v20, v20, v20 row_ror:8 row_mask:0xf bank_mask:0xf
    s_nop 1
    v_add_f32_dpp v20, v20, v20 row_ror:4 row_mask:0xf bank_mask:0xf
    s_nop 1
    v_add_f32_dpp v21, v21, v21 row_ror:8 row_mask:0xf bank_mask:0xf
    s_nop 1
    v_add_f32_dpp v21, v21, v21 row_ror:4 row_mask:0xf bank_mask:0xf
    s_nop 1
    v_add_f32_dpp v22, v22, v22 row_ror:8 row_mask:0xf bank_mask:0xf
    s_nop 1
    v_add_f32_dpp v22, v22, v22 row_ror:4 row_mask:0xf bank_mask:0xf
    s_nop 1
    v_add_f32_dpp v23, v23, v23 row_ror:8 row_mask:0xf bank_mask:0xf
    s_nop 1
    v_add_f32_dpp v23, v23, v23 row_ror:4 row_mask:0xf bank_mask:0xf
    v_mov_b32 v24, v20
    s_nop 1
    v_permlane16_swap_b32 v20, v24
    s_nop 1
    v_add_f32 v20, v20, v24
    v_mov_b32 v24, v20
    s_nop 1
    v_permlane32_swap_b32 v20, v24
    s_nop 1
    v_add_f32 v20, v20, v24
    v_mov_b32 v24, v21
    s_nop 1
    v_permlane16_swap_b32 v21, v24
    s_nop 1
    v_add_f32 v21, v21, v24
    v_mov_b32 v24, v21
    s_nop 1
    v_permlane32_swap_b32 v21, v24
    s_nop 1
    v_add_f32 v21, v21, v24
    v_mov_b32 v24, v22
    s_nop 1
    v_permlane16_swap_b32 v22, v24
    s_nop 1
    v_add_f32 v22, v22, v24
    v_mov_b32 v24, v22
    s_nop 1
    v_permlane32_swap_b32 v22, v24
    s_nop 1
    v_add_f32 v22, v22, v24
    v_mov_b32 v24, v23
    s_nop 1
    v_permlane16_swap_b32 v23, v24
    s_nop 1
    v_add_f32 v23, v23, v24
    v_mov_b32 v24, v23
    s_nop 1
    v_permlane32_swap_b32 v23, v24
    s_nop 1
    v_add_f32 v23, v23, v24
    ds_write_b128 v6, v[20:23] offset:12800
    s_waitcnt lgkmcnt(0)
    s_barrier
    ds_read_b32 v24, v7 offset:12800
    ds_read_b32 v25, v7 offset:12864
    ds_read_b32 v26, v7 offset:12928
    ds_read_b32 v27, v7 offset:12992
    ds_read_b32 v28, v7 offset:13056
    ds_read_b32 v29, v7 offset:13120
    ds_read_b32 v30, v7 offset:13184
    ds_read_b32 v31, v7 offset:13248
    s_waitcnt lgkmcnt(0)
    v_add_f32 v24, v24, v25
    v_add_f32 v26, v26, v27
    v_add_f32 v28, v28, v29
    v_add_f32 v30, v30, v31
    v_add_f32 v24, v24, v26
    v_add_f32 v28, v28, v30
    v_add_f32 v24, v24, v28
    v_cvt_pk_bf16_f32 v24, v24, v24
    v_and_b32 v24, 0xffff0000, v24
    v_mul_f32 v24, v24, v42
    v_cvt_pk_bf16_f32 v24, v24, v24
    v_and_b32 v24, 0xffff0000, v24
    v_add_f32 v24, v24, v40
    v_cvt_pk_bf16_f32 v24, v24, v24
    v_cmp_gt_u32 vcc, 16, v0
    s_and_saveexec_b64 s[58:59], vcc
    s_cbranch_execz L_endB
    buffer_store_short v24, v5, s[36:39], s60 offen
    s_mov_b64 exec, s[58:59]
L_endB:
L_end:
    s_endpgm
L_codeend:

.section .rodata,"a"
.p2align 6
.amdhsa_kernel recurrent_scan__compressed_kv_cla__dense_activation_gelu__decode_kernel
  .amdhsa_next_free_vgpr 256
  .amdhsa_next_free_sgpr 102
  .amdhsa_accum_offset 256
  .amdhsa_group_segment_fixed_size 0
  .amdhsa_kernarg_size 112
  .amdhsa_user_sgpr_count 2
  .amdhsa_user_sgpr_kernarg_segment_ptr 1
  .amdhsa_system_sgpr_workgroup_id_x 1
.end_amdhsa_kernel
```
